```python
import torch

def _softmax(x, axis=-1):
    return torch.softmax(x, dim=axis)
def _gelu(x):
    return torch.nn.functional.gelu(x, approximate="tanh")
def _silu(x):
    return torch.nn.functional.silu(x)
def _sigmoid(x):
    return torch.sigmoid(x)
def _layernorm(x, axis=-1, eps=1e-5):
    m = x.mean(dim=axis, keepdim=True)
    v = x.var(dim=axis, keepdim=True, unbiased=False)
    return (x - m) / torch.sqrt(v + eps)
def _scatter_add(tgt, idx, src, axis=0):
    return tgt.clone().index_add_(axis, idx, src)
def _segment_sum(src, seg, n):
    out = torch.zeros((n,) + src.shape[1:], dtype=src.dtype)
    return out.index_add_(0, seg, src)
def _pad(x, pw):
    flat = tuple(v for pair in reversed(pw) for v in pair)
    return torch.nn.functional.pad(x, flat)

kernel_name = 'concat_heads__grouped_kv_mqa__compressed_kv_cla__prompt'

def setup_inputs():

    _w = (lambda a: (lambda t: t.to(torch.bfloat16) if t.is_floating_point() else t)(torch.as_tensor(a)))
    def _A_setup():
        B, S, D, H = 1, 2048, 1024, 32
        Dh = D // H
        return {
            "x": _w((lambda *s: torch.randn(*s, dtype=torch.bfloat16) * 0.05)(B, S, D)),
            "wq": _w((lambda *s: torch.randn(*s, dtype=torch.bfloat16) * 0.8)(D, H * Dh)),
            "wk": _w((lambda *s: torch.randn(*s, dtype=torch.bfloat16) * 0.8)(D, Dh)),
            "wv": _w((lambda *s: torch.randn(*s, dtype=torch.bfloat16) * 0.05)(D, Dh)),
            "wo": _w((lambda *s: torch.randn(*s, dtype=torch.bfloat16) * 0.05)(H * Dh, D)),
        }
    _A_in = _A_setup()

    def _B_setup():
        B, H, Sq, Sk, D, M = 1, 32, 2048, 2048, 128, 1024
        Dc = 4 * D
        return {
            "x": _w((lambda *s: torch.randn(*s, dtype=torch.bfloat16) * 1.6)(B, Sq, M)),
            "c_kv": _w((lambda *s: torch.randn(*s, dtype=torch.bfloat16) * 0.2)(B, Sk, Dc)),
            "w_q": _w((lambda *s: torch.randn(*s, dtype=torch.bfloat16) * 6.4)(M, H, D) * (M ** -0.5)),
            "w_uk": _w((lambda *s: torch.randn(*s, dtype=torch.bfloat16) * 6.4)(Dc, H, D) * (Dc ** -0.5)),
            "w_uv": _w((lambda *s: torch.randn(*s, dtype=torch.bfloat16) * 0.2)(Dc, H, D) * (Dc ** -0.5)),
            "w_o": _w((lambda *s: torch.randn(*s, dtype=torch.bfloat16) * 0.2)(H, D, M) * ((H * D) ** -0.5)),
        }
    _B_in = _B_setup()

    return {
        "A_x": _A_in["x"],
        "A_wq": _A_in["wq"],
        "A_wk": _A_in["wk"],
        "A_wv": _A_in["wv"],
        "A_wo": _A_in["wo"],
        "B_x": _B_in["x"],
        "B_c_kv": _B_in["c_kv"],
        "B_w_q": _B_in["w_q"],
        "B_w_uk": _B_in["w_uk"],
        "B_w_uv": _B_in["w_uv"],
        "B_w_o": _B_in["w_o"],
    }

def reference(A_x, A_wq, A_wk, A_wv, A_wo, B_x, B_c_kv, B_w_q, B_w_uk, B_w_uv, B_w_o):
    def _A_ref(x, wq, wk, wv, wo):
        B, S, D = x.shape
        H = 32
        Dh = D // H
        q = (lambda x, *d: x.permute(*d))((x @ wq).reshape(B, S, H, Dh), 0, 2, 1, 3)
        k = x @ wk
        v = x @ wv
        scores = torch.einsum("bhqd,bkd->bhqk", q, k) * (Dh ** -0.5)
        p = _softmax(scores, axis=-1)
        o = torch.einsum("bhqk,bkd->bhqd", p, v)
        return (lambda x, *d: x.permute(*d))(o, 0, 2, 1, 3).reshape(B, S, H * Dh) @ wo

    def _B_ref(x, c_kv, w_q, w_uk, w_uv, w_o):
        B, Sq, M = x.shape[0], x.shape[1], x.shape[2]
        Sk = c_kv.shape[1]
        H, D = w_q.shape[1], w_q.shape[2]
        q = torch.einsum("bqm,mhd->bhqd", x, w_q)
        k = torch.einsum("bkc,chd->bhkd", c_kv, w_uk)
        v = torch.einsum("bkc,chd->bhkd", c_kv, w_uv)
        scores = torch.einsum("bhqd,bhkd->bhqk", q, k) * (D ** -0.5)
        off = Sk - Sq
        qi = torch.arange(Sq)[:, None]
        kj = torch.arange(Sk)[None, :]
        cmask = kj <= (qi + off)
        scores = torch.where(cmask[None, None], scores, -1e9)
        p = _softmax(scores, axis=-1)
        ctx = torch.einsum("bhqk,bhkd->bhqd", p, v)
        return torch.einsum("bhqd,hdm->bqm", ctx, w_o)

    a = _A_ref(A_x, A_wq, A_wk, A_wv, A_wo)
    b = _B_ref(B_x, B_c_kv, B_w_q, B_w_uk, B_w_uv, B_w_o)
    return torch.concatenate([a, b], axis=-1)
```

```asm
; @launch kernel=k1_proj_kernel grid=(576,1,1) block=(512,1,1) lds=131072
; @launch kernel=k2_attn_kernel grid=(256,1,1) block=(512,1,1) lds=102400
; @launch kernel=k3_out_kernel grid=(256,1,1) block=(512,1,1) lds=131072
.amdgcn_target "amdgcn-amd-amdhsa--gfx950"
.text
.globl k1_proj_kernel
.p2align 8
.type k1_proj_kernel,@function
k1_proj_kernel:
  s_load_dwordx16 s[32:47], s[0:1], 0
  s_load_dwordx8 s[48:55], s[0:1], 64
  s_load_dwordx4 s[56:59], s[0:1], 96
  s_cmp_ge_u32 s2, 576
  s_cbranch_scc1 L_k1_end
  s_waitcnt lgkmcnt(0)
  s_cmp_ge_u32 s2, 512
  s_cbranch_scc1 L_k1_kva
  s_cmp_ge_u32 s2, 384
  s_cbranch_scc1 L_k1_qa
  s_cmp_lt_u32 s2, 128
  s_cbranch_scc1 L_k1_qb
  s_cmp_lt_u32 s2, 256
  s_cbranch_scc1 L_k1_kb
  s_branch L_k1_vb
L_k1_qb:
  s_sub_u32 s60, s2, 0
  s_and_b32 s63, s60, 7
  s_lshr_b32 s60, s60, 3
  s_and_b32 s61, s63, 1
  s_lshl_b32 s61, s61, 2
  s_and_b32 s62, s60, 3
  s_add_u32 s61, s61, s62
  s_lshr_b32 s63, s63, 1
  s_mul_i32 s63, s63, 4
  s_lshr_b32 s62, s60, 2
  s_add_u32 s62, s62, s63
  s_mul_i32 s63, s61, 524288
  s_add_u32 s4, s42, 0x0
  s_addc_u32 s5, s43, 0
  s_add_u32 s4, s4, s63
  s_addc_u32 s5, s5, 0
  s_sub_u32 s6, 0x400000, s63
  s_mov_b32 s7, 0x00020000
  s_mul_i32 s63, s62, 512
  s_add_u32 s8, s46, 0x0
  s_addc_u32 s9, s47, 0
  s_add_u32 s8, s8, s63
  s_addc_u32 s9, s9, 0
  s_sub_u32 s10, 0x800000, s63
  s_mov_b32 s11, 0x00020000
  s_mul_i32 s63, s61, 2097152
  s_mul_i32 s60, s62, 512
  s_add_u32 s63, s63, s60
  s_add_u32 s12, s58, 0x800000
  s_addc_u32 s13, s59, 0
  s_add_u32 s12, s12, s63
  s_addc_u32 s13, s13, 0
  s_sub_u32 s14, 0x1000000, s63
  s_mov_b32 s15, 0x00020000
  s_mov_b32 s16, 2048
  s_mov_b32 s17, 8192
  s_mov_b32 s18, 8192
  s_mov_b32 s19, 16
  s_mov_b32 s20, 0x3e0293ee
  s_branch L_k1_gemm
L_k1_kb:
  s_sub_u32 s60, s2, 128
  s_and_b32 s63, s60, 7
  s_lshr_b32 s60, s60, 3
  s_and_b32 s61, s63, 1
  s_lshl_b32 s61, s61, 2
  s_and_b32 s62, s60, 3
  s_add_u32 s61, s61, s62
  s_lshr_b32 s63, s63, 1
  s_mul_i32 s63, s63, 4
  s_lshr_b32 s62, s60, 2
  s_add_u32 s62, s62, s63
  s_mul_i32 s63, s61, 262144
  s_add_u32 s4, s44, 0x0
  s_addc_u32 s5, s45, 0
  s_add_u32 s4, s4, s63
  s_addc_u32 s5, s5, 0
  s_sub_u32 s6, 0x200000, s63
  s_mov_b32 s7, 0x00020000
  s_mul_i32 s63, s62, 512
  s_add_u32 s8, s48, 0x0
  s_addc_u32 s9, s49, 0
  s_add_u32 s8, s8, s63
  s_addc_u32 s9, s9, 0
  s_sub_u32 s10, 0x400000, s63
  s_mov_b32 s11, 0x00020000
  s_mul_i32 s63, s61, 2097152
  s_mul_i32 s60, s62, 512
  s_add_u32 s63, s63, s60
  s_add_u32 s12, s58, 0x1800000
  s_addc_u32 s13, s59, 0
  s_add_u32 s12, s12, s63
  s_addc_u32 s13, s13, 0
  s_sub_u32 s14, 0x1000000, s63
  s_mov_b32 s15, 0x00020000
  s_mov_b32 s16, 1024
  s_mov_b32 s17, 8192
  s_mov_b32 s18, 8192
  s_mov_b32 s19, 8
  s_mov_b32 s20, 0x3f800000
  s_branch L_k1_gemm
L_k1_vb:
  s_sub_u32 s60, s2, 256
  s_and_b32 s63, s60, 7
  s_lshr_b32 s60, s60, 3
  s_and_b32 s61, s63, 1
  s_lshl_b32 s61, s61, 2
  s_and_b32 s62, s60, 3
  s_add_u32 s61, s61, s62
  s_lshr_b32 s63, s63, 1
  s_mul_i32 s63, s63, 4
  s_lshr_b32 s62, s60, 2
  s_add_u32 s62, s62, s63
  s_mul_i32 s63, s61, 262144
  s_add_u32 s4, s44, 0x0
  s_addc_u32 s5, s45, 0
  s_add_u32 s4, s4, s63
  s_addc_u32 s5, s5, 0
  s_sub_u32 s6, 0x200000, s63
  s_mov_b32 s7, 0x00020000
  s_mul_i32 s63, s62, 512
  s_add_u32 s8, s50, 0x0
  s_addc_u32 s9, s51, 0
  s_add_u32 s8, s8, s63
  s_addc_u32 s9, s9, 0
  s_sub_u32 s10, 0x400000, s63
  s_mov_b32 s11, 0x00020000
  s_mul_i32 s63, s61, 2097152
  s_mul_i32 s60, s62, 512
  s_add_u32 s63, s63, s60
  s_add_u32 s12, s58, 0x2800000
  s_addc_u32 s13, s59, 0
  s_add_u32 s12, s12, s63
  s_addc_u32 s13, s13, 0
  s_sub_u32 s14, 0x1000000, s63
  s_mov_b32 s15, 0x00020000
  s_mov_b32 s16, 1024
  s_mov_b32 s17, 8192
  s_mov_b32 s18, 8192
  s_mov_b32 s19, 8
  s_mov_b32 s20, 0x3f800000
  s_branch L_k1_gemm
L_k1_gemm:
  v_and_b32 v1, 63, v0
  v_lshrrev_b32 v17, 6, v0
  s_nop 0
  v_readfirstlane_b32 s21, v17
  s_nop 3
  s_lshl_b32 s26, s21, 10
  s_and_b32 s27, s21, 1
  s_lshl_b32 s28, s27, 2
  v_lshrrev_b32 v17, 4, v1
  v_or_b32 v17, s28, v17
  v_and_b32 v18, 7, v1
  v_xor_b32 v17, v17, v18
  v_lshlrev_b32 v17, 4, v17
  v_lshrrev_b32 v18, 3, v1
  s_lshl_b32 s28, s21, 3
  v_add_u32 v18, s28, v18
  v_add_u32 v19, 0, v18
  v_mul_lo_u32 v19, v19, s16
  v_add_u32 v2, v19, v17
  v_add_u32 v19, 64, v18
  v_mul_lo_u32 v19, v19, s16
  v_add_u32 v3, v19, v17
  v_add_u32 v19, 128, v18
  v_mul_lo_u32 v19, v19, s16
  v_add_u32 v4, v19, v17
  v_add_u32 v19, 192, v18
  v_mul_lo_u32 v19, v19, s16
  v_add_u32 v5, v19, v17
  v_lshrrev_b32 v17, 5, v1
  s_lshl_b32 s28, s27, 1
  v_or_b32 v18, s28, v17
  v_lshlrev_b32 v18, 2, v18
  s_lshr_b32 s28, s21, 2
  s_lshl_b32 s28, s28, 1
  v_or_b32 v18, s28, v18
  v_and_b32 v19, 31, v1
  v_xor_b32 v18, v18, v19
  v_lshlrev_b32 v18, 4, v18
  s_lshl_b32 s28, s21, 1
  v_add_u32 v17, s28, v17
  v_add_u32 v19, 0, v17
  v_mul_lo_u32 v19, v19, s17
  v_add_u32 v6, v19, v18
  v_add_u32 v19, 16, v17
  v_mul_lo_u32 v19, v19, s17
  v_add_u32 v7, v19, v18
  v_add_u32 v19, 32, v17
  v_mul_lo_u32 v19, v19, s17
  v_add_u32 v8, v19, v18
  v_add_u32 v19, 48, v17
  v_mul_lo_u32 v19, v19, s17
  v_add_u32 v9, v19, v18
  s_and_b32 s27, s21, 1
  s_lshr_b32 s28, s21, 1
  s_and_b32 s28, s28, 3
  v_and_b32 v17, 15, v1
  s_mul_i32 s22, s27, 128
  v_add_u32 v17, s22, v17
  v_lshlrev_b32 v17, 7, v17
  v_lshrrev_b32 v18, 4, v1
  v_bfe_u32 v19, v1, 1, 3
  v_xor_b32 v19, v19, v18
  v_xor_b32 v20, 0, v19
  v_lshl_add_u32 v10, v20, 4, v17
  v_xor_b32 v20, 4, v19
  v_lshl_add_u32 v11, v20, 4, v17
  v_bfe_u32 v17, v1, 2, 2
  v_lshl_add_u32 v18, v18, 3, v17
  v_mul_u32_u24 v18, 512, v18
  v_and_b32 v19, 1, v1
  v_lshl_add_u32 v18, v19, 3, v18
  v_add_u32 v18, 0x10000, v18
  v_lshlrev_b32 v17, 2, v17
  v_bfe_u32 v19, v1, 4, 1
  v_lshl_or_b32 v17, v19, 1, v17
  v_bfe_u32 v19, v1, 1, 1
  s_mul_i32 s22, s28, 8
  v_add_u32 v19, s22, v19
  v_add_u32 v20, 0, v19
  v_xor_b32 v20, v20, v17
  v_lshl_add_u32 v12, v20, 4, v18
  v_add_u32 v20, 2, v19
  v_xor_b32 v20, v20, v17
  v_lshl_add_u32 v13, v20, 4, v18
  v_add_u32 v20, 4, v19
  v_xor_b32 v20, v20, v17
  v_lshl_add_u32 v14, v20, 4, v18
  v_add_u32 v20, 6, v19
  v_xor_b32 v20, v20, v17
  v_lshl_add_u32 v15, v20, 4, v18
  s_lshl_b32 s24, s17, 6
  s_and_b32 s27, s21, 3
  s_lshl_b32 s27, s27, 4
  v_add_u32 v17, s27, v1
  s_and_b32 s27, s62, 3
  s_lshl_b32 s27, s27, 6
  v_add_u32 v18, s27, v17
  v_mul_lo_u32 v18, v18, s16
  s_and_b32 s27, s61, 3
  s_lshl_b32 s27, s27, 6
  v_add_u32 v17, s27, v17
  v_lshrrev_b32 v19, 2, v17
  v_mul_lo_u32 v19, v19, s17
  v_and_b32 v20, 3, v17
  v_lshl_add_u32 v19, v20, 7, v19
  s_cmp_ge_u32 s21, 4
  s_cselect_b64 vcc, -1, 0
  v_cndmask_b32 v22, v18, v19, vcc
  v_mov_b32 v18, 0x7f000000
  v_cmp_gt_u32 vcc, 16, v1
  s_nop 1
  v_cndmask_b32 v22, v18, v22, vcc
  s_mov_b32 s22, 0
  s_mov_b32 s23, 0
  s_add_u32 m0, s26, 0x0
  s_nop 0
  buffer_load_dwordx4 v2, s[4:7], s22 offen lds
  s_add_u32 m0, s26, 0x2000
  s_nop 0
  buffer_load_dwordx4 v3, s[4:7], s22 offen lds
  s_add_u32 m0, s26, 0x4000
  s_nop 0
  buffer_load_dwordx4 v4, s[4:7], s22 offen lds
  s_add_u32 m0, s26, 0x6000
  s_nop 0
  buffer_load_dwordx4 v5, s[4:7], s22 offen lds
  s_add_u32 m0, s26, 0x10000
  s_nop 0
  buffer_load_dwordx4 v6, s[8:11], s23 offen lds
  s_add_u32 m0, s26, 0x12000
  s_nop 0
  buffer_load_dwordx4 v7, s[8:11], s23 offen lds
  s_add_u32 m0, s26, 0x14000
  s_nop 0
  buffer_load_dwordx4 v8, s[8:11], s23 offen lds
  s_add_u32 m0, s26, 0x16000
  s_nop 0
  buffer_load_dwordx4 v9, s[8:11], s23 offen lds
  s_add_u32 s22, s22, 128
  s_add_u32 s23, s23, s24
  s_sub_u32 s64, s2, 128
  s_cmp_lt_u32 s64, 256
  s_cselect_b32 s64, s64, 0
  s_cselect_b32 s65, 0, 0x7f000000
  v_lshlrev_b32 v120, 4, v0
  v_add_u32 v120, s65, v120
  s_mul_i32 s72, s64, 16384
  s_add_u32 s68, s32, 0x0
  s_addc_u32 s69, s33, 0
  s_add_u32 s68, s68, s72
  s_addc_u32 s69, s69, 0
  s_sub_u32 s70, 0x400000, s72
  s_mov_b32 s71, 0x00020000
  s_mov_b32 s72, 0
  buffer_load_dwordx4 v[124:127], v120, s[68:71], s72 offen
  s_mov_b32 s72, 8192
  buffer_load_dwordx4 v[124:127], v120, s[68:71], s72 offen
  s_mul_i32 s72, s64, 8192
  s_add_u32 s68, s34, 0x0
  s_addc_u32 s69, s35, 0
  s_add_u32 s68, s68, s72
  s_addc_u32 s69, s69, 0
  s_sub_u32 s70, 0x200000, s72
  s_mov_b32 s71, 0x00020000
  s_mov_b32 s72, 0
  buffer_load_dwordx4 v[124:127], v120, s[68:71], s72 offen
  s_getpc_b64 s[68:69]
L_k1_pc:
  s_sub_u32 s68, s68, L_k1_pc-k1_proj_kernel
  s_subb_u32 s69, s69, 0
  s_cmp_lt_u32 s2, 16
  s_cselect_b32 s70, L_code_end-k1_proj_kernel, 0
  s_mov_b32 s71, 0x00020000
  v_lshlrev_b32 v121, 4, v0
  s_mov_b32 s72, 0
  buffer_load_dwordx4 v[124:127], v121, s[68:71], s72 offen
  s_mov_b32 s72, 8192
  buffer_load_dwordx4 v[124:127], v121, s[68:71], s72 offen
  s_mov_b32 s72, 16384
  buffer_load_dwordx4 v[124:127], v121, s[68:71], s72 offen
  s_mov_b32 s72, 24576
  buffer_load_dwordx4 v[124:127], v121, s[68:71], s72 offen
  s_mov_b32 s72, 32768
  buffer_load_dwordx4 v[124:127], v121, s[68:71], s72 offen
  s_and_b32 s64, s64, 7
  s_lshl_b32 s72, s64, 13
  s_add_u32 s68, s36, 0x0
  s_addc_u32 s69, s37, 0
  s_add_u32 s68, s68, s72
  s_addc_u32 s69, s69, 0
  s_sub_u32 s70, 0x10000, s72
  s_mov_b32 s71, 0x00020000
  buffer_load_dwordx4 v[124:127], v120, s[68:71], 0 offen
  s_lshl_b32 s72, s64, 13
  s_add_u32 s68, s38, 0x0
  s_addc_u32 s69, s39, 0
  s_add_u32 s68, s68, s72
  s_addc_u32 s69, s69, 0
  s_sub_u32 s70, 0x10000, s72
  s_mov_b32 s71, 0x00020000
  buffer_load_dwordx4 v[124:127], v120, s[68:71], 0 offen
  v_mov_b32 v128, 0
  v_mov_b32 v129, 0
  v_mov_b32 v130, 0
  v_mov_b32 v131, 0
  v_mov_b32 v132, 0
  v_mov_b32 v133, 0
  v_mov_b32 v134, 0
  v_mov_b32 v135, 0
  v_mov_b32 v136, 0
  v_mov_b32 v137, 0
  v_mov_b32 v138, 0
  v_mov_b32 v139, 0
  v_mov_b32 v140, 0
  v_mov_b32 v141, 0
  v_mov_b32 v142, 0
  v_mov_b32 v143, 0
  v_mov_b32 v144, 0
  v_mov_b32 v145, 0
  v_mov_b32 v146, 0
  v_mov_b32 v147, 0
  v_mov_b32 v148, 0
  v_mov_b32 v149, 0
  v_mov_b32 v150, 0
  v_mov_b32 v151, 0
  v_mov_b32 v152, 0
  v_mov_b32 v153, 0
  v_mov_b32 v154, 0
  v_mov_b32 v155, 0
  v_mov_b32 v156, 0
  v_mov_b32 v157, 0
  v_mov_b32 v158, 0
  v_mov_b32 v159, 0
  v_mov_b32 v160, 0
  v_mov_b32 v161, 0
  v_mov_b32 v162, 0
  v_mov_b32 v163, 0
  v_mov_b32 v164, 0
  v_mov_b32 v165, 0
  v_mov_b32 v166, 0
  v_mov_b32 v167, 0
  v_mov_b32 v168, 0
  v_mov_b32 v169, 0
  v_mov_b32 v170, 0
  v_mov_b32 v171, 0
  v_mov_b32 v172, 0
  v_mov_b32 v173, 0
  v_mov_b32 v174, 0
  v_mov_b32 v175, 0
  v_mov_b32 v176, 0
  v_mov_b32 v177, 0
  v_mov_b32 v178, 0
  v_mov_b32 v179, 0
  v_mov_b32 v180, 0
  v_mov_b32 v181, 0
  v_mov_b32 v182, 0
  v_mov_b32 v183, 0
  v_mov_b32 v184, 0
  v_mov_b32 v185, 0
  v_mov_b32 v186, 0
  v_mov_b32 v187, 0
  v_mov_b32 v188, 0
  v_mov_b32 v189, 0
  v_mov_b32 v190, 0
  v_mov_b32 v191, 0
  v_mov_b32 v192, 0
  v_mov_b32 v193, 0
  v_mov_b32 v194, 0
  v_mov_b32 v195, 0
  v_mov_b32 v196, 0
  v_mov_b32 v197, 0
  v_mov_b32 v198, 0
  v_mov_b32 v199, 0
  v_mov_b32 v200, 0
  v_mov_b32 v201, 0
  v_mov_b32 v202, 0
  v_mov_b32 v203, 0
  v_mov_b32 v204, 0
  v_mov_b32 v205, 0
  v_mov_b32 v206, 0
  v_mov_b32 v207, 0
  v_mov_b32 v208, 0
  v_mov_b32 v209, 0
  v_mov_b32 v210, 0
  v_mov_b32 v211, 0
  v_mov_b32 v212, 0
  v_mov_b32 v213, 0
  v_mov_b32 v214, 0
  v_mov_b32 v215, 0
  v_mov_b32 v216, 0
  v_mov_b32 v217, 0
  v_mov_b32 v218, 0
  v_mov_b32 v219, 0
  v_mov_b32 v220, 0
  v_mov_b32 v221, 0
  v_mov_b32 v222, 0
  v_mov_b32 v223, 0
  v_mov_b32 v224, 0
  v_mov_b32 v225, 0
  v_mov_b32 v226, 0
  v_mov_b32 v227, 0
  v_mov_b32 v228, 0
  v_mov_b32 v229, 0
  v_mov_b32 v230, 0
  v_mov_b32 v231, 0
  v_mov_b32 v232, 0
  v_mov_b32 v233, 0
  v_mov_b32 v234, 0
  v_mov_b32 v235, 0
  v_mov_b32 v236, 0
  v_mov_b32 v237, 0
  v_mov_b32 v238, 0
  v_mov_b32 v239, 0
  v_mov_b32 v240, 0
  v_mov_b32 v241, 0
  v_mov_b32 v242, 0
  v_mov_b32 v243, 0
  v_mov_b32 v244, 0
  v_mov_b32 v245, 0
  v_mov_b32 v246, 0
  v_mov_b32 v247, 0
  v_mov_b32 v248, 0
  v_mov_b32 v249, 0
  v_mov_b32 v250, 0
  v_mov_b32 v251, 0
  v_mov_b32 v252, 0
  v_mov_b32 v253, 0
  v_mov_b32 v254, 0
  v_mov_b32 v255, 0
  s_mov_b32 s25, 0
  s_cmp_ge_u32 s21, 4
  s_cbranch_scc1 L_k1_g1
  s_waitcnt vmcnt(10)
  s_barrier
L_k1_g0loop:
  ds_read_b64_tr_b16 v[56:57], v12 offset:0
  ds_read_b64_tr_b16 v[58:59], v12 offset:2048
  ds_read_b64_tr_b16 v[60:61], v13 offset:0
  ds_read_b64_tr_b16 v[62:63], v13 offset:2048
  ds_read_b64_tr_b16 v[64:65], v14 offset:0
  ds_read_b64_tr_b16 v[66:67], v14 offset:2048
  ds_read_b64_tr_b16 v[68:69], v15 offset:0
  ds_read_b64_tr_b16 v[70:71], v15 offset:2048
  ds_read_b128 v[24:27], v10 offset:0
  ds_read_b128 v[28:31], v10 offset:2048
  ds_read_b128 v[32:35], v10 offset:4096
  ds_read_b128 v[36:39], v10 offset:6144
  ds_read_b128 v[40:43], v10 offset:8192
  ds_read_b128 v[44:47], v10 offset:10240
  ds_read_b128 v[48:51], v10 offset:12288
  ds_read_b128 v[52:55], v10 offset:14336
  s_add_u32 m0, s26, 0x8000
  s_nop 0
  buffer_load_dwordx4 v2, s[4:7], s22 offen lds
  s_add_u32 m0, s26, 0xa000
  s_nop 0
  buffer_load_dwordx4 v3, s[4:7], s22 offen lds
  s_waitcnt lgkmcnt(0)
  s_barrier
  v_mfma_f32_16x16x32_bf16 v[128:131], v[56:59], v[24:27], v[128:131]
  v_mfma_f32_16x16x32_bf16 v[160:163], v[60:63], v[24:27], v[160:163]
  s_add_u32 m0, s26, 0xc000
  s_nop 0
  buffer_load_dwordx4 v4, s[4:7], s22 offen lds
  v_mfma_f32_16x16x32_bf16 v[192:195], v[64:67], v[24:27], v[192:195]
  v_mfma_f32_16x16x32_bf16 v[224:227], v[68:71], v[24:27], v[224:227]
  v_mfma_f32_16x16x32_bf16 v[132:135], v[56:59], v[28:31], v[132:135]
  v_mfma_f32_16x16x32_bf16 v[164:167], v[60:63], v[28:31], v[164:167]
  v_mfma_f32_16x16x32_bf16 v[196:199], v[64:67], v[28:31], v[196:199]
  v_mfma_f32_16x16x32_bf16 v[228:231], v[68:71], v[28:31], v[228:231]
  v_mfma_f32_16x16x32_bf16 v[136:139], v[56:59], v[32:35], v[136:139]
  v_mfma_f32_16x16x32_bf16 v[168:171], v[60:63], v[32:35], v[168:171]
  s_add_u32 m0, s26, 0xe000
  s_nop 0
  buffer_load_dwordx4 v5, s[4:7], s22 offen lds
  v_mfma_f32_16x16x32_bf16 v[200:203], v[64:67], v[32:35], v[200:203]
  v_mfma_f32_16x16x32_bf16 v[232:235], v[68:71], v[32:35], v[232:235]
  v_mfma_f32_16x16x32_bf16 v[140:143], v[56:59], v[36:39], v[140:143]
  v_mfma_f32_16x16x32_bf16 v[172:175], v[60:63], v[36:39], v[172:175]
  v_mfma_f32_16x16x32_bf16 v[204:207], v[64:67], v[36:39], v[204:207]
  v_mfma_f32_16x16x32_bf16 v[236:239], v[68:71], v[36:39], v[236:239]
  v_mfma_f32_16x16x32_bf16 v[144:147], v[56:59], v[40:43], v[144:147]
  v_mfma_f32_16x16x32_bf16 v[176:179], v[60:63], v[40:43], v[176:179]
  s_add_u32 m0, s26, 0x18000
  s_nop 0
  buffer_load_dwordx4 v6, s[8:11], s23 offen lds
  v_mfma_f32_16x16x32_bf16 v[208:211], v[64:67], v[40:43], v[208:211]
  v_mfma_f32_16x16x32_bf16 v[240:243], v[68:71], v[40:43], v[240:243]
  v_mfma_f32_16x16x32_bf16 v[148:151], v[56:59], v[44:47], v[148:151]
  v_mfma_f32_16x16x32_bf16 v[180:183], v[60:63], v[44:47], v[180:183]
  v_mfma_f32_16x16x32_bf16 v[212:215], v[64:67], v[44:47], v[212:215]
  v_mfma_f32_16x16x32_bf16 v[244:247], v[68:71], v[44:47], v[244:247]
  v_mfma_f32_16x16x32_bf16 v[152:155], v[56:59], v[48:51], v[152:155]
  v_mfma_f32_16x16x32_bf16 v[184:187], v[60:63], v[48:51], v[184:187]
  s_add_u32 m0, s26, 0x1a000
  s_nop 0
  buffer_load_dwordx4 v7, s[8:11], s23 offen lds
  v_mfma_f32_16x16x32_bf16 v[216:219], v[64:67], v[48:51], v[216:219]
  v_mfma_f32_16x16x32_bf16 v[248:251], v[68:71], v[48:51], v[248:251]
  v_mfma_f32_16x16x32_bf16 v[156:159], v[56:59], v[52:55], v[156:159]
  v_mfma_f32_16x16x32_bf16 v[188:191], v[60:63], v[52:55], v[188:191]
  v_mfma_f32_16x16x32_bf16 v[220:223], v[64:67], v[52:55], v[220:223]
  v_mfma_f32_16x16x32_bf16 v[252:255], v[68:71], v[52:55], v[252:255]
  s_barrier
  ds_read_b64_tr_b16 v[56:57], v12 offset:16384
  ds_read_b64_tr_b16 v[58:59], v12 offset:18432
  ds_read_b64_tr_b16 v[60:61], v13 offset:16384
  ds_read_b64_tr_b16 v[62:63], v13 offset:18432
  ds_read_b64_tr_b16 v[64:65], v14 offset:16384
  ds_read_b64_tr_b16 v[66:67], v14 offset:18432
  ds_read_b64_tr_b16 v[68:69], v15 offset:16384
  ds_read_b64_tr_b16 v[70:71], v15 offset:18432
  ds_read_b128 v[24:27], v11 offset:0
  ds_read_b128 v[28:31], v11 offset:2048
  ds_read_b128 v[32:35], v11 offset:4096
  ds_read_b128 v[36:39], v11 offset:6144
  ds_read_b128 v[40:43], v11 offset:8192
  ds_read_b128 v[44:47], v11 offset:10240
  ds_read_b128 v[48:51], v11 offset:12288
  ds_read_b128 v[52:55], v11 offset:14336
  s_add_u32 m0, s26, 0x1c000
  s_nop 0
  buffer_load_dwordx4 v8, s[8:11], s23 offen lds
  s_add_u32 m0, s26, 0x1e000
  s_nop 0
  buffer_load_dwordx4 v9, s[8:11], s23 offen lds
  s_add_u32 s29, s22, 384
  buffer_load_dword v23, v22, s[4:7], s29 offen
  s_add_u32 s22, s22, 128
  s_add_u32 s23, s23, s24
  s_waitcnt lgkmcnt(0)
  s_barrier
  v_mfma_f32_16x16x32_bf16 v[128:131], v[56:59], v[24:27], v[128:131]
  v_mfma_f32_16x16x32_bf16 v[160:163], v[60:63], v[24:27], v[160:163]
  v_mfma_f32_16x16x32_bf16 v[192:195], v[64:67], v[24:27], v[192:195]
  v_mfma_f32_16x16x32_bf16 v[224:227], v[68:71], v[24:27], v[224:227]
  v_mfma_f32_16x16x32_bf16 v[132:135], v[56:59], v[28:31], v[132:135]
  v_mfma_f32_16x16x32_bf16 v[164:167], v[60:63], v[28:31], v[164:167]
  v_mfma_f32_16x16x32_bf16 v[196:199], v[64:67], v[28:31], v[196:199]
  v_mfma_f32_16x16x32_bf16 v[228:231], v[68:71], v[28:31], v[228:231]
  v_mfma_f32_16x16x32_bf16 v[136:139], v[56:59], v[32:35], v[136:139]
  v_mfma_f32_16x16x32_bf16 v[168:171], v[60:63], v[32:35], v[168:171]
  v_mfma_f32_16x16x32_bf16 v[200:203], v[64:67], v[32:35], v[200:203]
  v_mfma_f32_16x16x32_bf16 v[232:235], v[68:71], v[32:35], v[232:235]
  v_mfma_f32_16x16x32_bf16 v[140:143], v[56:59], v[36:39], v[140:143]
  v_mfma_f32_16x16x32_bf16 v[172:175], v[60:63], v[36:39], v[172:175]
  v_mfma_f32_16x16x32_bf16 v[204:207], v[64:67], v[36:39], v[204:207]
  v_mfma_f32_16x16x32_bf16 v[236:239], v[68:71], v[36:39], v[236:239]
  v_mfma_f32_16x16x32_bf16 v[144:147], v[56:59], v[40:43], v[144:147]
  v_mfma_f32_16x16x32_bf16 v[176:179], v[60:63], v[40:43], v[176:179]
  v_mfma_f32_16x16x32_bf16 v[208:211], v[64:67], v[40:43], v[208:211]
  v_mfma_f32_16x16x32_bf16 v[240:243], v[68:71], v[40:43], v[240:243]
  v_mfma_f32_16x16x32_bf16 v[148:151], v[56:59], v[44:47], v[148:151]
  v_mfma_f32_16x16x32_bf16 v[180:183], v[60:63], v[44:47], v[180:183]
  v_mfma_f32_16x16x32_bf16 v[212:215], v[64:67], v[44:47], v[212:215]
  v_mfma_f32_16x16x32_bf16 v[244:247], v[68:71], v[44:47], v[244:247]
  v_mfma_f32_16x16x32_bf16 v[152:155], v[56:59], v[48:51], v[152:155]
  v_mfma_f32_16x16x32_bf16 v[184:187], v[60:63], v[48:51], v[184:187]
  v_mfma_f32_16x16x32_bf16 v[216:219], v[64:67], v[48:51], v[216:219]
  v_mfma_f32_16x16x32_bf16 v[248:251], v[68:71], v[48:51], v[248:251]
  v_mfma_f32_16x16x32_bf16 v[156:159], v[56:59], v[52:55], v[156:159]
  v_mfma_f32_16x16x32_bf16 v[188:191], v[60:63], v[52:55], v[188:191]
  v_mfma_f32_16x16x32_bf16 v[220:223], v[64:67], v[52:55], v[220:223]
  v_mfma_f32_16x16x32_bf16 v[252:255], v[68:71], v[52:55], v[252:255]
  s_waitcnt vmcnt(1)
  s_barrier
  s_add_u32 s27, s25, 2
  s_cmp_lt_u32 s27, s19
  s_cbranch_scc0 L_skip_1
  ds_read_b64_tr_b16 v[56:57], v12 offset:32768
  ds_read_b64_tr_b16 v[58:59], v12 offset:34816
  ds_read_b64_tr_b16 v[60:61], v13 offset:32768
  ds_read_b64_tr_b16 v[62:63], v13 offset:34816
  ds_read_b64_tr_b16 v[64:65], v14 offset:32768
  ds_read_b64_tr_b16 v[66:67], v14 offset:34816
  ds_read_b64_tr_b16 v[68:69], v15 offset:32768
  ds_read_b64_tr_b16 v[70:71], v15 offset:34816
  ds_read_b128 v[24:27], v10 offset:32768
  ds_read_b128 v[28:31], v10 offset:34816
  ds_read_b128 v[32:35], v10 offset:36864
  ds_read_b128 v[36:39], v10 offset:38912
  ds_read_b128 v[40:43], v10 offset:40960
  ds_read_b128 v[44:47], v10 offset:43008
  ds_read_b128 v[48:51], v10 offset:45056
  ds_read_b128 v[52:55], v10 offset:47104
  s_add_u32 m0, s26, 0x0
  s_nop 0
  buffer_load_dwordx4 v2, s[4:7], s22 offen lds
  s_add_u32 m0, s26, 0x2000
  s_nop 0
  buffer_load_dwordx4 v3, s[4:7], s22 offen lds
  s_waitcnt lgkmcnt(0)
  s_barrier
  v_mfma_f32_16x16x32_bf16 v[128:131], v[56:59], v[24:27], v[128:131]
  v_mfma_f32_16x16x32_bf16 v[160:163], v[60:63], v[24:27], v[160:163]
  s_add_u32 m0, s26, 0x4000
  s_nop 0
  buffer_load_dwordx4 v4, s[4:7], s22 offen lds
  v_mfma_f32_16x16x32_bf16 v[192:195], v[64:67], v[24:27], v[192:195]
  v_mfma_f32_16x16x32_bf16 v[224:227], v[68:71], v[24:27], v[224:227]
  v_mfma_f32_16x16x32_bf16 v[132:135], v[56:59], v[28:31], v[132:135]
  v_mfma_f32_16x16x32_bf16 v[164:167], v[60:63], v[28:31], v[164:167]
  v_mfma_f32_16x16x32_bf16 v[196:199], v[64:67], v[28:31], v[196:199]
  v_mfma_f32_16x16x32_bf16 v[228:231], v[68:71], v[28:31], v[228:231]
  v_mfma_f32_16x16x32_bf16 v[136:139], v[56:59], v[32:35], v[136:139]
  v_mfma_f32_16x16x32_bf16 v[168:171], v[60:63], v[32:35], v[168:171]
  s_add_u32 m0, s26, 0x6000
  s_nop 0
  buffer_load_dwordx4 v5, s[4:7], s22 offen lds
  v_mfma_f32_16x16x32_bf16 v[200:203], v[64:67], v[32:35], v[200:203]
  v_mfma_f32_16x16x32_bf16 v[232:235], v[68:71], v[32:35], v[232:235]
  v_mfma_f32_16x16x32_bf16 v[140:143], v[56:59], v[36:39], v[140:143]
  v_mfma_f32_16x16x32_bf16 v[172:175], v[60:63], v[36:39], v[172:175]
  v_mfma_f32_16x16x32_bf16 v[204:207], v[64:67], v[36:39], v[204:207]
  v_mfma_f32_16x16x32_bf16 v[236:239], v[68:71], v[36:39], v[236:239]
  v_mfma_f32_16x16x32_bf16 v[144:147], v[56:59], v[40:43], v[144:147]
  v_mfma_f32_16x16x32_bf16 v[176:179], v[60:63], v[40:43], v[176:179]
  s_add_u32 m0, s26, 0x10000
  s_nop 0
  buffer_load_dwordx4 v6, s[8:11], s23 offen lds
  v_mfma_f32_16x16x32_bf16 v[208:211], v[64:67], v[40:43], v[208:211]
  v_mfma_f32_16x16x32_bf16 v[240:243], v[68:71], v[40:43], v[240:243]
  v_mfma_f32_16x16x32_bf16 v[148:151], v[56:59], v[44:47], v[148:151]
  v_mfma_f32_16x16x32_bf16 v[180:183], v[60:63], v[44:47], v[180:183]
  v_mfma_f32_16x16x32_bf16 v[212:215], v[64:67], v[44:47], v[212:215]
  v_mfma_f32_16x16x32_bf16 v[244:247], v[68:71], v[44:47], v[244:247]
  v_mfma_f32_16x16x32_bf16 v[152:155], v[56:59], v[48:51], v[152:155]
  v_mfma_f32_16x16x32_bf16 v[184:187], v[60:63], v[48:51], v[184:187]
  s_add_u32 m0, s26, 0x12000
  s_nop 0
  buffer_load_dwordx4 v7, s[8:11], s23 offen lds
  v_mfma_f32_16x16x32_bf16 v[216:219], v[64:67], v[48:51], v[216:219]
  v_mfma_f32_16x16x32_bf16 v[248:251], v[68:71], v[48:51], v[248:251]
  v_mfma_f32_16x16x32_bf16 v[156:159], v[56:59], v[52:55], v[156:159]
  v_mfma_f32_16x16x32_bf16 v[188:191], v[60:63], v[52:55], v[188:191]
  v_mfma_f32_16x16x32_bf16 v[220:223], v[64:67], v[52:55], v[220:223]
  v_mfma_f32_16x16x32_bf16 v[252:255], v[68:71], v[52:55], v[252:255]
  s_barrier
  ds_read_b64_tr_b16 v[56:57], v12 offset:49152
  ds_read_b64_tr_b16 v[58:59], v12 offset:51200
  ds_read_b64_tr_b16 v[60:61], v13 offset:49152
  ds_read_b64_tr_b16 v[62:63], v13 offset:51200
  ds_read_b64_tr_b16 v[64:65], v14 offset:49152
  ds_read_b64_tr_b16 v[66:67], v14 offset:51200
  ds_read_b64_tr_b16 v[68:69], v15 offset:49152
  ds_read_b64_tr_b16 v[70:71], v15 offset:51200
  ds_read_b128 v[24:27], v11 offset:32768
  ds_read_b128 v[28:31], v11 offset:34816
  ds_read_b128 v[32:35], v11 offset:36864
  ds_read_b128 v[36:39], v11 offset:38912
  ds_read_b128 v[40:43], v11 offset:40960
  ds_read_b128 v[44:47], v11 offset:43008
  ds_read_b128 v[48:51], v11 offset:45056
  ds_read_b128 v[52:55], v11 offset:47104
  s_add_u32 m0, s26, 0x14000
  s_nop 0
  buffer_load_dwordx4 v8, s[8:11], s23 offen lds
  s_add_u32 m0, s26, 0x16000
  s_nop 0
  buffer_load_dwordx4 v9, s[8:11], s23 offen lds
  s_add_u32 s29, s22, 384
  buffer_load_dword v23, v22, s[4:7], s29 offen
  s_add_u32 s22, s22, 128
  s_add_u32 s23, s23, s24
  s_waitcnt lgkmcnt(0)
  s_barrier
  s_branch L_done_2
L_skip_1:
  ds_read_b64_tr_b16 v[56:57], v12 offset:32768
  ds_read_b64_tr_b16 v[58:59], v12 offset:34816
  ds_read_b64_tr_b16 v[60:61], v13 offset:32768
  ds_read_b64_tr_b16 v[62:63], v13 offset:34816
  ds_read_b64_tr_b16 v[64:65], v14 offset:32768
  ds_read_b64_tr_b16 v[66:67], v14 offset:34816
  ds_read_b64_tr_b16 v[68:69], v15 offset:32768
  ds_read_b64_tr_b16 v[70:71], v15 offset:34816
  ds_read_b128 v[24:27], v10 offset:32768
  ds_read_b128 v[28:31], v10 offset:34816
  ds_read_b128 v[32:35], v10 offset:36864
  ds_read_b128 v[36:39], v10 offset:38912
  ds_read_b128 v[40:43], v10 offset:40960
  ds_read_b128 v[44:47], v10 offset:43008
  ds_read_b128 v[48:51], v10 offset:45056
  ds_read_b128 v[52:55], v10 offset:47104
  s_waitcnt lgkmcnt(0)
  s_barrier
  v_mfma_f32_16x16x32_bf16 v[128:131], v[56:59], v[24:27], v[128:131]
  v_mfma_f32_16x16x32_bf16 v[160:163], v[60:63], v[24:27], v[160:163]
  v_mfma_f32_16x16x32_bf16 v[192:195], v[64:67], v[24:27], v[192:195]
  v_mfma_f32_16x16x32_bf16 v[224:227], v[68:71], v[24:27], v[224:227]
  v_mfma_f32_16x16x32_bf16 v[132:135], v[56:59], v[28:31], v[132:135]
  v_mfma_f32_16x16x32_bf16 v[164:167], v[60:63], v[28:31], v[164:167]
  v_mfma_f32_16x16x32_bf16 v[196:199], v[64:67], v[28:31], v[196:199]
  v_mfma_f32_16x16x32_bf16 v[228:231], v[68:71], v[28:31], v[228:231]
  v_mfma_f32_16x16x32_bf16 v[136:139], v[56:59], v[32:35], v[136:139]
  v_mfma_f32_16x16x32_bf16 v[168:171], v[60:63], v[32:35], v[168:171]
  v_mfma_f32_16x16x32_bf16 v[200:203], v[64:67], v[32:35], v[200:203]
  v_mfma_f32_16x16x32_bf16 v[232:235], v[68:71], v[32:35], v[232:235]
  v_mfma_f32_16x16x32_bf16 v[140:143], v[56:59], v[36:39], v[140:143]
  v_mfma_f32_16x16x32_bf16 v[172:175], v[60:63], v[36:39], v[172:175]
  v_mfma_f32_16x16x32_bf16 v[204:207], v[64:67], v[36:39], v[204:207]
  v_mfma_f32_16x16x32_bf16 v[236:239], v[68:71], v[36:39], v[236:239]
  v_mfma_f32_16x16x32_bf16 v[144:147], v[56:59], v[40:43], v[144:147]
  v_mfma_f32_16x16x32_bf16 v[176:179], v[60:63], v[40:43], v[176:179]
  v_mfma_f32_16x16x32_bf16 v[208:211], v[64:67], v[40:43], v[208:211]
  v_mfma_f32_16x16x32_bf16 v[240:243], v[68:71], v[40:43], v[240:243]
  v_mfma_f32_16x16x32_bf16 v[148:151], v[56:59], v[44:47], v[148:151]
  v_mfma_f32_16x16x32_bf16 v[180:183], v[60:63], v[44:47], v[180:183]
  v_mfma_f32_16x16x32_bf16 v[212:215], v[64:67], v[44:47], v[212:215]
  v_mfma_f32_16x16x32_bf16 v[244:247], v[68:71], v[44:47], v[244:247]
  v_mfma_f32_16x16x32_bf16 v[152:155], v[56:59], v[48:51], v[152:155]
  v_mfma_f32_16x16x32_bf16 v[184:187], v[60:63], v[48:51], v[184:187]
  v_mfma_f32_16x16x32_bf16 v[216:219], v[64:67], v[48:51], v[216:219]
  v_mfma_f32_16x16x32_bf16 v[248:251], v[68:71], v[48:51], v[248:251]
  v_mfma_f32_16x16x32_bf16 v[156:159], v[56:59], v[52:55], v[156:159]
  v_mfma_f32_16x16x32_bf16 v[188:191], v[60:63], v[52:55], v[188:191]
  v_mfma_f32_16x16x32_bf16 v[220:223], v[64:67], v[52:55], v[220:223]
  v_mfma_f32_16x16x32_bf16 v[252:255], v[68:71], v[52:55], v[252:255]
  s_barrier
  ds_read_b64_tr_b16 v[56:57], v12 offset:49152
  ds_read_b64_tr_b16 v[58:59], v12 offset:51200
  ds_read_b64_tr_b16 v[60:61], v13 offset:49152
  ds_read_b64_tr_b16 v[62:63], v13 offset:51200
  ds_read_b64_tr_b16 v[64:65], v14 offset:49152
  ds_read_b64_tr_b16 v[66:67], v14 offset:51200
  ds_read_b64_tr_b16 v[68:69], v15 offset:49152
  ds_read_b64_tr_b16 v[70:71], v15 offset:51200
  ds_read_b128 v[24:27], v11 offset:32768
  ds_read_b128 v[28:31], v11 offset:34816
  ds_read_b128 v[32:35], v11 offset:36864
  ds_read_b128 v[36:39], v11 offset:38912
  ds_read_b128 v[40:43], v11 offset:40960
  ds_read_b128 v[44:47], v11 offset:43008
  ds_read_b128 v[48:51], v11 offset:45056
  ds_read_b128 v[52:55], v11 offset:47104
  s_waitcnt lgkmcnt(0)
  s_barrier
L_done_2:
  v_mfma_f32_16x16x32_bf16 v[128:131], v[56:59], v[24:27], v[128:131]
  v_mfma_f32_16x16x32_bf16 v[160:163], v[60:63], v[24:27], v[160:163]
  v_mfma_f32_16x16x32_bf16 v[192:195], v[64:67], v[24:27], v[192:195]
  v_mfma_f32_16x16x32_bf16 v[224:227], v[68:71], v[24:27], v[224:227]
  v_mfma_f32_16x16x32_bf16 v[132:135], v[56:59], v[28:31], v[132:135]
  v_mfma_f32_16x16x32_bf16 v[164:167], v[60:63], v[28:31], v[164:167]
  v_mfma_f32_16x16x32_bf16 v[196:199], v[64:67], v[28:31], v[196:199]
  v_mfma_f32_16x16x32_bf16 v[228:231], v[68:71], v[28:31], v[228:231]
  v_mfma_f32_16x16x32_bf16 v[136:139], v[56:59], v[32:35], v[136:139]
  v_mfma_f32_16x16x32_bf16 v[168:171], v[60:63], v[32:35], v[168:171]
  v_mfma_f32_16x16x32_bf16 v[200:203], v[64:67], v[32:35], v[200:203]
  v_mfma_f32_16x16x32_bf16 v[232:235], v[68:71], v[32:35], v[232:235]
  v_mfma_f32_16x16x32_bf16 v[140:143], v[56:59], v[36:39], v[140:143]
  v_mfma_f32_16x16x32_bf16 v[172:175], v[60:63], v[36:39], v[172:175]
  v_mfma_f32_16x16x32_bf16 v[204:207], v[64:67], v[36:39], v[204:207]
  v_mfma_f32_16x16x32_bf16 v[236:239], v[68:71], v[36:39], v[236:239]
  v_mfma_f32_16x16x32_bf16 v[144:147], v[56:59], v[40:43], v[144:147]
  v_mfma_f32_16x16x32_bf16 v[176:179], v[60:63], v[40:43], v[176:179]
  v_mfma_f32_16x16x32_bf16 v[208:211], v[64:67], v[40:43], v[208:211]
  v_mfma_f32_16x16x32_bf16 v[240:243], v[68:71], v[40:43], v[240:243]
  v_mfma_f32_16x16x32_bf16 v[148:151], v[56:59], v[44:47], v[148:151]
  v_mfma_f32_16x16x32_bf16 v[180:183], v[60:63], v[44:47], v[180:183]
  v_mfma_f32_16x16x32_bf16 v[212:215], v[64:67], v[44:47], v[212:215]
  v_mfma_f32_16x16x32_bf16 v[244:247], v[68:71], v[44:47], v[244:247]
  v_mfma_f32_16x16x32_bf16 v[152:155], v[56:59], v[48:51], v[152:155]
  v_mfma_f32_16x16x32_bf16 v[184:187], v[60:63], v[48:51], v[184:187]
  v_mfma_f32_16x16x32_bf16 v[216:219], v[64:67], v[48:51], v[216:219]
  v_mfma_f32_16x16x32_bf16 v[248:251], v[68:71], v[48:51], v[248:251]
  v_mfma_f32_16x16x32_bf16 v[156:159], v[56:59], v[52:55], v[156:159]
  v_mfma_f32_16x16x32_bf16 v[188:191], v[60:63], v[52:55], v[188:191]
  v_mfma_f32_16x16x32_bf16 v[220:223], v[64:67], v[52:55], v[220:223]
  v_mfma_f32_16x16x32_bf16 v[252:255], v[68:71], v[52:55], v[252:255]
  s_waitcnt vmcnt(1)
  s_barrier
  s_add_u32 s25, s25, 2
  s_cmp_lt_u32 s25, s19
  s_cbranch_scc1 L_k1_g0loop
  s_branch L_k1_epi
L_k1_g1:
  s_add_u32 m0, s26, 0x8000
  s_nop 0
  buffer_load_dwordx4 v2, s[4:7], s22 offen lds
  s_add_u32 m0, s26, 0xa000
  s_nop 0
  buffer_load_dwordx4 v3, s[4:7], s22 offen lds
  s_add_u32 m0, s26, 0xc000
  s_nop 0
  buffer_load_dwordx4 v4, s[4:7], s22 offen lds
  s_add_u32 m0, s26, 0xe000
  s_nop 0
  buffer_load_dwordx4 v5, s[4:7], s22 offen lds
  s_waitcnt vmcnt(14)
  s_barrier
  s_barrier
L_k1_g1loop:
  ds_read_b64_tr_b16 v[56:57], v12 offset:0
  ds_read_b64_tr_b16 v[58:59], v12 offset:2048
  ds_read_b64_tr_b16 v[60:61], v13 offset:0
  ds_read_b64_tr_b16 v[62:63], v13 offset:2048
  ds_read_b64_tr_b16 v[64:65], v14 offset:0
  ds_read_b64_tr_b16 v[66:67], v14 offset:2048
  ds_read_b64_tr_b16 v[68:69], v15 offset:0
  ds_read_b64_tr_b16 v[70:71], v15 offset:2048
  ds_read_b128 v[24:27], v10 offset:0
  ds_read_b128 v[28:31], v10 offset:2048
  ds_read_b128 v[32:35], v10 offset:4096
  ds_read_b128 v[36:39], v10 offset:6144
  ds_read_b128 v[40:43], v10 offset:8192
  ds_read_b128 v[44:47], v10 offset:10240
  ds_read_b128 v[48:51], v10 offset:12288
  ds_read_b128 v[52:55], v10 offset:14336
  s_waitcnt lgkmcnt(0)
  s_barrier
  v_mfma_f32_16x16x32_bf16 v[128:131], v[56:59], v[24:27], v[128:131]
  s_add_u32 m0, s26, 0x18000
  s_nop 0
  buffer_load_dwordx4 v6, s[8:11], s23 offen lds
  v_mfma_f32_16x16x32_bf16 v[160:163], v[60:63], v[24:27], v[160:163]
  v_mfma_f32_16x16x32_bf16 v[192:195], v[64:67], v[24:27], v[192:195]
  v_mfma_f32_16x16x32_bf16 v[224:227], v[68:71], v[24:27], v[224:227]
  v_mfma_f32_16x16x32_bf16 v[132:135], v[56:59], v[28:31], v[132:135]
  v_mfma_f32_16x16x32_bf16 v[164:167], v[60:63], v[28:31], v[164:167]
  v_mfma_f32_16x16x32_bf16 v[196:199], v[64:67], v[28:31], v[196:199]
  s_add_u32 m0, s26, 0x1a000
  s_nop 0
  buffer_load_dwordx4 v7, s[8:11], s23 offen lds
  v_mfma_f32_16x16x32_bf16 v[228:231], v[68:71], v[28:31], v[228:231]
  v_mfma_f32_16x16x32_bf16 v[136:139], v[56:59], v[32:35], v[136:139]
  v_mfma_f32_16x16x32_bf16 v[168:171], v[60:63], v[32:35], v[168:171]
  v_mfma_f32_16x16x32_bf16 v[200:203], v[64:67], v[32:35], v[200:203]
  v_mfma_f32_16x16x32_bf16 v[232:235], v[68:71], v[32:35], v[232:235]
  v_mfma_f32_16x16x32_bf16 v[140:143], v[56:59], v[36:39], v[140:143]
  s_add_u32 m0, s26, 0x1c000
  s_nop 0
  buffer_load_dwordx4 v8, s[8:11], s23 offen lds
  v_mfma_f32_16x16x32_bf16 v[172:175], v[60:63], v[36:39], v[172:175]
  v_mfma_f32_16x16x32_bf16 v[204:207], v[64:67], v[36:39], v[204:207]
  v_mfma_f32_16x16x32_bf16 v[236:239], v[68:71], v[36:39], v[236:239]
  v_mfma_f32_16x16x32_bf16 v[144:147], v[56:59], v[40:43], v[144:147]
  v_mfma_f32_16x16x32_bf16 v[176:179], v[60:63], v[40:43], v[176:179]
  v_mfma_f32_16x16x32_bf16 v[208:211], v[64:67], v[40:43], v[208:211]
  s_add_u32 m0, s26, 0x1e000
  s_nop 0
  buffer_load_dwordx4 v9, s[8:11], s23 offen lds
  v_mfma_f32_16x16x32_bf16 v[240:243], v[68:71], v[40:43], v[240:243]
  v_mfma_f32_16x16x32_bf16 v[148:151], v[56:59], v[44:47], v[148:151]
  v_mfma_f32_16x16x32_bf16 v[180:183], v[60:63], v[44:47], v[180:183]
  v_mfma_f32_16x16x32_bf16 v[212:215], v[64:67], v[44:47], v[212:215]
  v_mfma_f32_16x16x32_bf16 v[244:247], v[68:71], v[44:47], v[244:247]
  v_mfma_f32_16x16x32_bf16 v[152:155], v[56:59], v[48:51], v[152:155]
  s_mul_i32 s29, s24, 3
  s_add_u32 s29, s29, s23
  buffer_load_dword v23, v22, s[8:11], s29 offen
  s_add_u32 s22, s22, 128
  s_add_u32 s23, s23, s24
  v_mfma_f32_16x16x32_bf16 v[184:187], v[60:63], v[48:51], v[184:187]
  v_mfma_f32_16x16x32_bf16 v[216:219], v[64:67], v[48:51], v[216:219]
  v_mfma_f32_16x16x32_bf16 v[248:251], v[68:71], v[48:51], v[248:251]
  v_mfma_f32_16x16x32_bf16 v[156:159], v[56:59], v[52:55], v[156:159]
  v_mfma_f32_16x16x32_bf16 v[188:191], v[60:63], v[52:55], v[188:191]
  v_mfma_f32_16x16x32_bf16 v[220:223], v[64:67], v[52:55], v[220:223]
  v_mfma_f32_16x16x32_bf16 v[252:255], v[68:71], v[52:55], v[252:255]
  s_barrier
  ds_read_b64_tr_b16 v[56:57], v12 offset:16384
  ds_read_b64_tr_b16 v[58:59], v12 offset:18432
  ds_read_b64_tr_b16 v[60:61], v13 offset:16384
  ds_read_b64_tr_b16 v[62:63], v13 offset:18432
  ds_read_b64_tr_b16 v[64:65], v14 offset:16384
  ds_read_b64_tr_b16 v[66:67], v14 offset:18432
  ds_read_b64_tr_b16 v[68:69], v15 offset:16384
  ds_read_b64_tr_b16 v[70:71], v15 offset:18432
  ds_read_b128 v[24:27], v11 offset:0
  ds_read_b128 v[28:31], v11 offset:2048
  ds_read_b128 v[32:35], v11 offset:4096
  ds_read_b128 v[36:39], v11 offset:6144
  ds_read_b128 v[40:43], v11 offset:8192
  ds_read_b128 v[44:47], v11 offset:10240
  ds_read_b128 v[48:51], v11 offset:12288
  ds_read_b128 v[52:55], v11 offset:14336
  s_waitcnt vmcnt(1) lgkmcnt(0)
  s_barrier
  s_add_u32 s27, s25, 2
  s_cmp_lt_u32 s27, s19
  s_cbranch_scc0 L_skip_3
  v_mfma_f32_16x16x32_bf16 v[128:131], v[56:59], v[24:27], v[128:131]
  v_mfma_f32_16x16x32_bf16 v[160:163], v[60:63], v[24:27], v[160:163]
  s_add_u32 m0, s26, 0x0
  s_nop 0
  buffer_load_dwordx4 v2, s[4:7], s22 offen lds
  v_mfma_f32_16x16x32_bf16 v[192:195], v[64:67], v[24:27], v[192:195]
  v_mfma_f32_16x16x32_bf16 v[224:227], v[68:71], v[24:27], v[224:227]
  v_mfma_f32_16x16x32_bf16 v[132:135], v[56:59], v[28:31], v[132:135]
  v_mfma_f32_16x16x32_bf16 v[164:167], v[60:63], v[28:31], v[164:167]
  v_mfma_f32_16x16x32_bf16 v[196:199], v[64:67], v[28:31], v[196:199]
  v_mfma_f32_16x16x32_bf16 v[228:231], v[68:71], v[28:31], v[228:231]
  v_mfma_f32_16x16x32_bf16 v[136:139], v[56:59], v[32:35], v[136:139]
  v_mfma_f32_16x16x32_bf16 v[168:171], v[60:63], v[32:35], v[168:171]
  s_add_u32 m0, s26, 0x2000
  s_nop 0
  buffer_load_dwordx4 v3, s[4:7], s22 offen lds
  v_mfma_f32_16x16x32_bf16 v[200:203], v[64:67], v[32:35], v[200:203]
  v_mfma_f32_16x16x32_bf16 v[232:235], v[68:71], v[32:35], v[232:235]
  v_mfma_f32_16x16x32_bf16 v[140:143], v[56:59], v[36:39], v[140:143]
  v_mfma_f32_16x16x32_bf16 v[172:175], v[60:63], v[36:39], v[172:175]
  v_mfma_f32_16x16x32_bf16 v[204:207], v[64:67], v[36:39], v[204:207]
  v_mfma_f32_16x16x32_bf16 v[236:239], v[68:71], v[36:39], v[236:239]
  v_mfma_f32_16x16x32_bf16 v[144:147], v[56:59], v[40:43], v[144:147]
  v_mfma_f32_16x16x32_bf16 v[176:179], v[60:63], v[40:43], v[176:179]
  s_add_u32 m0, s26, 0x4000
  s_nop 0
  buffer_load_dwordx4 v4, s[4:7], s22 offen lds
  v_mfma_f32_16x16x32_bf16 v[208:211], v[64:67], v[40:43], v[208:211]
  v_mfma_f32_16x16x32_bf16 v[240:243], v[68:71], v[40:43], v[240:243]
  v_mfma_f32_16x16x32_bf16 v[148:151], v[56:59], v[44:47], v[148:151]
  v_mfma_f32_16x16x32_bf16 v[180:183], v[60:63], v[44:47], v[180:183]
  v_mfma_f32_16x16x32_bf16 v[212:215], v[64:67], v[44:47], v[212:215]
  v_mfma_f32_16x16x32_bf16 v[244:247], v[68:71], v[44:47], v[244:247]
  v_mfma_f32_16x16x32_bf16 v[152:155], v[56:59], v[48:51], v[152:155]
  v_mfma_f32_16x16x32_bf16 v[184:187], v[60:63], v[48:51], v[184:187]
  s_add_u32 m0, s26, 0x6000
  s_nop 0
  buffer_load_dwordx4 v5, s[4:7], s22 offen lds
  v_mfma_f32_16x16x32_bf16 v[216:219], v[64:67], v[48:51], v[216:219]
  v_mfma_f32_16x16x32_bf16 v[248:251], v[68:71], v[48:51], v[248:251]
  v_mfma_f32_16x16x32_bf16 v[156:159], v[56:59], v[52:55], v[156:159]
  v_mfma_f32_16x16x32_bf16 v[188:191], v[60:63], v[52:55], v[188:191]
  v_mfma_f32_16x16x32_bf16 v[220:223], v[64:67], v[52:55], v[220:223]
  v_mfma_f32_16x16x32_bf16 v[252:255], v[68:71], v[52:55], v[252:255]
  s_branch L_done_4
L_skip_3:
  v_mfma_f32_16x16x32_bf16 v[128:131], v[56:59], v[24:27], v[128:131]
  v_mfma_f32_16x16x32_bf16 v[160:163], v[60:63], v[24:27], v[160:163]
  v_mfma_f32_16x16x32_bf16 v[192:195], v[64:67], v[24:27], v[192:195]
  v_mfma_f32_16x16x32_bf16 v[224:227], v[68:71], v[24:27], v[224:227]
  v_mfma_f32_16x16x32_bf16 v[132:135], v[56:59], v[28:31], v[132:135]
  v_mfma_f32_16x16x32_bf16 v[164:167], v[60:63], v[28:31], v[164:167]
  v_mfma_f32_16x16x32_bf16 v[196:199], v[64:67], v[28:31], v[196:199]
  v_mfma_f32_16x16x32_bf16 v[228:231], v[68:71], v[28:31], v[228:231]
  v_mfma_f32_16x16x32_bf16 v[136:139], v[56:59], v[32:35], v[136:139]
  v_mfma_f32_16x16x32_bf16 v[168:171], v[60:63], v[32:35], v[168:171]
  v_mfma_f32_16x16x32_bf16 v[200:203], v[64:67], v[32:35], v[200:203]
  v_mfma_f32_16x16x32_bf16 v[232:235], v[68:71], v[32:35], v[232:235]
  v_mfma_f32_16x16x32_bf16 v[140:143], v[56:59], v[36:39], v[140:143]
  v_mfma_f32_16x16x32_bf16 v[172:175], v[60:63], v[36:39], v[172:175]
  v_mfma_f32_16x16x32_bf16 v[204:207], v[64:67], v[36:39], v[204:207]
  v_mfma_f32_16x16x32_bf16 v[236:239], v[68:71], v[36:39], v[236:239]
  v_mfma_f32_16x16x32_bf16 v[144:147], v[56:59], v[40:43], v[144:147]
  v_mfma_f32_16x16x32_bf16 v[176:179], v[60:63], v[40:43], v[176:179]
  v_mfma_f32_16x16x32_bf16 v[208:211], v[64:67], v[40:43], v[208:211]
  v_mfma_f32_16x16x32_bf16 v[240:243], v[68:71], v[40:43], v[240:243]
  v_mfma_f32_16x16x32_bf16 v[148:151], v[56:59], v[44:47], v[148:151]
  v_mfma_f32_16x16x32_bf16 v[180:183], v[60:63], v[44:47], v[180:183]
  v_mfma_f32_16x16x32_bf16 v[212:215], v[64:67], v[44:47], v[212:215]
  v_mfma_f32_16x16x32_bf16 v[244:247], v[68:71], v[44:47], v[244:247]
  v_mfma_f32_16x16x32_bf16 v[152:155], v[56:59], v[48:51], v[152:155]
  v_mfma_f32_16x16x32_bf16 v[184:187], v[60:63], v[48:51], v[184:187]
  v_mfma_f32_16x16x32_bf16 v[216:219], v[64:67], v[48:51], v[216:219]
  v_mfma_f32_16x16x32_bf16 v[248:251], v[68:71], v[48:51], v[248:251]
  v_mfma_f32_16x16x32_bf16 v[156:159], v[56:59], v[52:55], v[156:159]
  v_mfma_f32_16x16x32_bf16 v[188:191], v[60:63], v[52:55], v[188:191]
  v_mfma_f32_16x16x32_bf16 v[220:223], v[64:67], v[52:55], v[220:223]
  v_mfma_f32_16x16x32_bf16 v[252:255], v[68:71], v[52:55], v[252:255]
L_done_4:
  s_barrier
  ds_read_b64_tr_b16 v[56:57], v12 offset:32768
  ds_read_b64_tr_b16 v[58:59], v12 offset:34816
  ds_read_b64_tr_b16 v[60:61], v13 offset:32768
  ds_read_b64_tr_b16 v[62:63], v13 offset:34816
  ds_read_b64_tr_b16 v[64:65], v14 offset:32768
  ds_read_b64_tr_b16 v[66:67], v14 offset:34816
  ds_read_b64_tr_b16 v[68:69], v15 offset:32768
  ds_read_b64_tr_b16 v[70:71], v15 offset:34816
  ds_read_b128 v[24:27], v10 offset:32768
  ds_read_b128 v[28:31], v10 offset:34816
  ds_read_b128 v[32:35], v10 offset:36864
  ds_read_b128 v[36:39], v10 offset:38912
  ds_read_b128 v[40:43], v10 offset:40960
  ds_read_b128 v[44:47], v10 offset:43008
  ds_read_b128 v[48:51], v10 offset:45056
  ds_read_b128 v[52:55], v10 offset:47104
  s_waitcnt lgkmcnt(0)
  s_barrier
  s_add_u32 s27, s25, 2
  s_cmp_lt_u32 s27, s19
  s_cbranch_scc0 L_skip_5
  v_mfma_f32_16x16x32_bf16 v[128:131], v[56:59], v[24:27], v[128:131]
  s_add_u32 m0, s26, 0x10000
  s_nop 0
  buffer_load_dwordx4 v6, s[8:11], s23 offen lds
  v_mfma_f32_16x16x32_bf16 v[160:163], v[60:63], v[24:27], v[160:163]
  v_mfma_f32_16x16x32_bf16 v[192:195], v[64:67], v[24:27], v[192:195]
  v_mfma_f32_16x16x32_bf16 v[224:227], v[68:71], v[24:27], v[224:227]
  v_mfma_f32_16x16x32_bf16 v[132:135], v[56:59], v[28:31], v[132:135]
  v_mfma_f32_16x16x32_bf16 v[164:167], v[60:63], v[28:31], v[164:167]
  v_mfma_f32_16x16x32_bf16 v[196:199], v[64:67], v[28:31], v[196:199]
  s_add_u32 m0, s26, 0x12000
  s_nop 0
  buffer_load_dwordx4 v7, s[8:11], s23 offen lds
  v_mfma_f32_16x16x32_bf16 v[228:231], v[68:71], v[28:31], v[228:231]
  v_mfma_f32_16x16x32_bf16 v[136:139], v[56:59], v[32:35], v[136:139]
  v_mfma_f32_16x16x32_bf16 v[168:171], v[60:63], v[32:35], v[168:171]
  v_mfma_f32_16x16x32_bf16 v[200:203], v[64:67], v[32:35], v[200:203]
  v_mfma_f32_16x16x32_bf16 v[232:235], v[68:71], v[32:35], v[232:235]
  v_mfma_f32_16x16x32_bf16 v[140:143], v[56:59], v[36:39], v[140:143]
  s_add_u32 m0, s26, 0x14000
  s_nop 0
  buffer_load_dwordx4 v8, s[8:11], s23 offen lds
  v_mfma_f32_16x16x32_bf16 v[172:175], v[60:63], v[36:39], v[172:175]
  v_mfma_f32_16x16x32_bf16 v[204:207], v[64:67], v[36:39], v[204:207]
  v_mfma_f32_16x16x32_bf16 v[236:239], v[68:71], v[36:39], v[236:239]
  v_mfma_f32_16x16x32_bf16 v[144:147], v[56:59], v[40:43], v[144:147]
  v_mfma_f32_16x16x32_bf16 v[176:179], v[60:63], v[40:43], v[176:179]
  v_mfma_f32_16x16x32_bf16 v[208:211], v[64:67], v[40:43], v[208:211]
  s_add_u32 m0, s26, 0x16000
  s_nop 0
  buffer_load_dwordx4 v9, s[8:11], s23 offen lds
  v_mfma_f32_16x16x32_bf16 v[240:243], v[68:71], v[40:43], v[240:243]
  v_mfma_f32_16x16x32_bf16 v[148:151], v[56:59], v[44:47], v[148:151]
  v_mfma_f32_16x16x32_bf16 v[180:183], v[60:63], v[44:47], v[180:183]
  v_mfma_f32_16x16x32_bf16 v[212:215], v[64:67], v[44:47], v[212:215]
  v_mfma_f32_16x16x32_bf16 v[244:247], v[68:71], v[44:47], v[244:247]
  v_mfma_f32_16x16x32_bf16 v[152:155], v[56:59], v[48:51], v[152:155]
  s_mul_i32 s29, s24, 3
  s_add_u32 s29, s29, s23
  buffer_load_dword v23, v22, s[8:11], s29 offen
  s_add_u32 s22, s22, 128
  s_add_u32 s23, s23, s24
  v_mfma_f32_16x16x32_bf16 v[184:187], v[60:63], v[48:51], v[184:187]
  v_mfma_f32_16x16x32_bf16 v[216:219], v[64:67], v[48:51], v[216:219]
  v_mfma_f32_16x16x32_bf16 v[248:251], v[68:71], v[48:51], v[248:251]
  v_mfma_f32_16x16x32_bf16 v[156:159], v[56:59], v[52:55], v[156:159]
  v_mfma_f32_16x16x32_bf16 v[188:191], v[60:63], v[52:55], v[188:191]
  v_mfma_f32_16x16x32_bf16 v[220:223], v[64:67], v[52:55], v[220:223]
  v_mfma_f32_16x16x32_bf16 v[252:255], v[68:71], v[52:55], v[252:255]
  s_branch L_done_6
L_skip_5:
  v_mfma_f32_16x16x32_bf16 v[128:131], v[56:59], v[24:27], v[128:131]
  v_mfma_f32_16x16x32_bf16 v[160:163], v[60:63], v[24:27], v[160:163]
  v_mfma_f32_16x16x32_bf16 v[192:195], v[64:67], v[24:27], v[192:195]
  v_mfma_f32_16x16x32_bf16 v[224:227], v[68:71], v[24:27], v[224:227]
  v_mfma_f32_16x16x32_bf16 v[132:135], v[56:59], v[28:31], v[132:135]
  v_mfma_f32_16x16x32_bf16 v[164:167], v[60:63], v[28:31], v[164:167]
  v_mfma_f32_16x16x32_bf16 v[196:199], v[64:67], v[28:31], v[196:199]
  v_mfma_f32_16x16x32_bf16 v[228:231], v[68:71], v[28:31], v[228:231]
  v_mfma_f32_16x16x32_bf16 v[136:139], v[56:59], v[32:35], v[136:139]
  v_mfma_f32_16x16x32_bf16 v[168:171], v[60:63], v[32:35], v[168:171]
  v_mfma_f32_16x16x32_bf16 v[200:203], v[64:67], v[32:35], v[200:203]
  v_mfma_f32_16x16x32_bf16 v[232:235], v[68:71], v[32:35], v[232:235]
  v_mfma_f32_16x16x32_bf16 v[140:143], v[56:59], v[36:39], v[140:143]
  v_mfma_f32_16x16x32_bf16 v[172:175], v[60:63], v[36:39], v[172:175]
  v_mfma_f32_16x16x32_bf16 v[204:207], v[64:67], v[36:39], v[204:207]
  v_mfma_f32_16x16x32_bf16 v[236:239], v[68:71], v[36:39], v[236:239]
  v_mfma_f32_16x16x32_bf16 v[144:147], v[56:59], v[40:43], v[144:147]
  v_mfma_f32_16x16x32_bf16 v[176:179], v[60:63], v[40:43], v[176:179]
  v_mfma_f32_16x16x32_bf16 v[208:211], v[64:67], v[40:43], v[208:211]
  v_mfma_f32_16x16x32_bf16 v[240:243], v[68:71], v[40:43], v[240:243]
  v_mfma_f32_16x16x32_bf16 v[148:151], v[56:59], v[44:47], v[148:151]
  v_mfma_f32_16x16x32_bf16 v[180:183], v[60:63], v[44:47], v[180:183]
  v_mfma_f32_16x16x32_bf16 v[212:215], v[64:67], v[44:47], v[212:215]
  v_mfma_f32_16x16x32_bf16 v[244:247], v[68:71], v[44:47], v[244:247]
  v_mfma_f32_16x16x32_bf16 v[152:155], v[56:59], v[48:51], v[152:155]
  v_mfma_f32_16x16x32_bf16 v[184:187], v[60:63], v[48:51], v[184:187]
  v_mfma_f32_16x16x32_bf16 v[216:219], v[64:67], v[48:51], v[216:219]
  v_mfma_f32_16x16x32_bf16 v[248:251], v[68:71], v[48:51], v[248:251]
  v_mfma_f32_16x16x32_bf16 v[156:159], v[56:59], v[52:55], v[156:159]
  v_mfma_f32_16x16x32_bf16 v[188:191], v[60:63], v[52:55], v[188:191]
  v_mfma_f32_16x16x32_bf16 v[220:223], v[64:67], v[52:55], v[220:223]
  v_mfma_f32_16x16x32_bf16 v[252:255], v[68:71], v[52:55], v[252:255]
L_done_6:
  s_barrier
  ds_read_b64_tr_b16 v[56:57], v12 offset:49152
  ds_read_b64_tr_b16 v[58:59], v12 offset:51200
  ds_read_b64_tr_b16 v[60:61], v13 offset:49152
  ds_read_b64_tr_b16 v[62:63], v13 offset:51200
  ds_read_b64_tr_b16 v[64:65], v14 offset:49152
  ds_read_b64_tr_b16 v[66:67], v14 offset:51200
  ds_read_b64_tr_b16 v[68:69], v15 offset:49152
  ds_read_b64_tr_b16 v[70:71], v15 offset:51200
  ds_read_b128 v[24:27], v11 offset:32768
  ds_read_b128 v[28:31], v11 offset:34816
  ds_read_b128 v[32:35], v11 offset:36864
  ds_read_b128 v[36:39], v11 offset:38912
  ds_read_b128 v[40:43], v11 offset:40960
  ds_read_b128 v[44:47], v11 offset:43008
  ds_read_b128 v[48:51], v11 offset:45056
  ds_read_b128 v[52:55], v11 offset:47104
  s_waitcnt vmcnt(1) lgkmcnt(0)
  s_barrier
  s_add_u32 s27, s25, 3
  s_cmp_lt_u32 s27, s19
  s_cbranch_scc0 L_skip_7
  v_mfma_f32_16x16x32_bf16 v[128:131], v[56:59], v[24:27], v[128:131]
  v_mfma_f32_16x16x32_bf16 v[160:163], v[60:63], v[24:27], v[160:163]
  s_add_u32 m0, s26, 0x8000
  s_nop 0
  buffer_load_dwordx4 v2, s[4:7], s22 offen lds
  v_mfma_f32_16x16x32_bf16 v[192:195], v[64:67], v[24:27], v[192:195]
  v_mfma_f32_16x16x32_bf16 v[224:227], v[68:71], v[24:27], v[224:227]
  v_mfma_f32_16x16x32_bf16 v[132:135], v[56:59], v[28:31], v[132:135]
  v_mfma_f32_16x16x32_bf16 v[164:167], v[60:63], v[28:31], v[164:167]
  v_mfma_f32_16x16x32_bf16 v[196:199], v[64:67], v[28:31], v[196:199]
  v_mfma_f32_16x16x32_bf16 v[228:231], v[68:71], v[28:31], v[228:231]
  v_mfma_f32_16x16x32_bf16 v[136:139], v[56:59], v[32:35], v[136:139]
  v_mfma_f32_16x16x32_bf16 v[168:171], v[60:63], v[32:35], v[168:171]
  s_add_u32 m0, s26, 0xa000
  s_nop 0
  buffer_load_dwordx4 v3, s[4:7], s22 offen lds
  v_mfma_f32_16x16x32_bf16 v[200:203], v[64:67], v[32:35], v[200:203]
  v_mfma_f32_16x16x32_bf16 v[232:235], v[68:71], v[32:35], v[232:235]
  v_mfma_f32_16x16x32_bf16 v[140:143], v[56:59], v[36:39], v[140:143]
  v_mfma_f32_16x16x32_bf16 v[172:175], v[60:63], v[36:39], v[172:175]
  v_mfma_f32_16x16x32_bf16 v[204:207], v[64:67], v[36:39], v[204:207]
  v_mfma_f32_16x16x32_bf16 v[236:239], v[68:71], v[36:39], v[236:239]
  v_mfma_f32_16x16x32_bf16 v[144:147], v[56:59], v[40:43], v[144:147]
  v_mfma_f32_16x16x32_bf16 v[176:179], v[60:63], v[40:43], v[176:179]
  s_add_u32 m0, s26, 0xc000
  s_nop 0
  buffer_load_dwordx4 v4, s[4:7], s22 offen lds
  v_mfma_f32_16x16x32_bf16 v[208:211], v[64:67], v[40:43], v[208:211]
  v_mfma_f32_16x16x32_bf16 v[240:243], v[68:71], v[40:43], v[240:243]
  v_mfma_f32_16x16x32_bf16 v[148:151], v[56:59], v[44:47], v[148:151]
  v_mfma_f32_16x16x32_bf16 v[180:183], v[60:63], v[44:47], v[180:183]
  v_mfma_f32_16x16x32_bf16 v[212:215], v[64:67], v[44:47], v[212:215]
  v_mfma_f32_16x16x32_bf16 v[244:247], v[68:71], v[44:47], v[244:247]
  v_mfma_f32_16x16x32_bf16 v[152:155], v[56:59], v[48:51], v[152:155]
  v_mfma_f32_16x16x32_bf16 v[184:187], v[60:63], v[48:51], v[184:187]
  s_add_u32 m0, s26, 0xe000
  s_nop 0
  buffer_load_dwordx4 v5, s[4:7], s22 offen lds
  v_mfma_f32_16x16x32_bf16 v[216:219], v[64:67], v[48:51], v[216:219]
  v_mfma_f32_16x16x32_bf16 v[248:251], v[68:71], v[48:51], v[248:251]
  v_mfma_f32_16x16x32_bf16 v[156:159], v[56:59], v[52:55], v[156:159]
  v_mfma_f32_16x16x32_bf16 v[188:191], v[60:63], v[52:55], v[188:191]
  v_mfma_f32_16x16x32_bf16 v[220:223], v[64:67], v[52:55], v[220:223]
  v_mfma_f32_16x16x32_bf16 v[252:255], v[68:71], v[52:55], v[252:255]
  s_branch L_done_8
L_skip_7:
  v_mfma_f32_16x16x32_bf16 v[128:131], v[56:59], v[24:27], v[128:131]
  v_mfma_f32_16x16x32_bf16 v[160:163], v[60:63], v[24:27], v[160:163]
  v_mfma_f32_16x16x32_bf16 v[192:195], v[64:67], v[24:27], v[192:195]
  v_mfma_f32_16x16x32_bf16 v[224:227], v[68:71], v[24:27], v[224:227]
  v_mfma_f32_16x16x32_bf16 v[132:135], v[56:59], v[28:31], v[132:135]
  v_mfma_f32_16x16x32_bf16 v[164:167], v[60:63], v[28:31], v[164:167]
  v_mfma_f32_16x16x32_bf16 v[196:199], v[64:67], v[28:31], v[196:199]
  v_mfma_f32_16x16x32_bf16 v[228:231], v[68:71], v[28:31], v[228:231]
  v_mfma_f32_16x16x32_bf16 v[136:139], v[56:59], v[32:35], v[136:139]
  v_mfma_f32_16x16x32_bf16 v[168:171], v[60:63], v[32:35], v[168:171]
  v_mfma_f32_16x16x32_bf16 v[200:203], v[64:67], v[32:35], v[200:203]
  v_mfma_f32_16x16x32_bf16 v[232:235], v[68:71], v[32:35], v[232:235]
  v_mfma_f32_16x16x32_bf16 v[140:143], v[56:59], v[36:39], v[140:143]
  v_mfma_f32_16x16x32_bf16 v[172:175], v[60:63], v[36:39], v[172:175]
  v_mfma_f32_16x16x32_bf16 v[204:207], v[64:67], v[36:39], v[204:207]
  v_mfma_f32_16x16x32_bf16 v[236:239], v[68:71], v[36:39], v[236:239]
  v_mfma_f32_16x16x32_bf16 v[144:147], v[56:59], v[40:43], v[144:147]
  v_mfma_f32_16x16x32_bf16 v[176:179], v[60:63], v[40:43], v[176:179]
  v_mfma_f32_16x16x32_bf16 v[208:211], v[64:67], v[40:43], v[208:211]
  v_mfma_f32_16x16x32_bf16 v[240:243], v[68:71], v[40:43], v[240:243]
  v_mfma_f32_16x16x32_bf16 v[148:151], v[56:59], v[44:47], v[148:151]
  v_mfma_f32_16x16x32_bf16 v[180:183], v[60:63], v[44:47], v[180:183]
  v_mfma_f32_16x16x32_bf16 v[212:215], v[64:67], v[44:47], v[212:215]
  v_mfma_f32_16x16x32_bf16 v[244:247], v[68:71], v[44:47], v[244:247]
  v_mfma_f32_16x16x32_bf16 v[152:155], v[56:59], v[48:51], v[152:155]
  v_mfma_f32_16x16x32_bf16 v[184:187], v[60:63], v[48:51], v[184:187]
  v_mfma_f32_16x16x32_bf16 v[216:219], v[64:67], v[48:51], v[216:219]
  v_mfma_f32_16x16x32_bf16 v[248:251], v[68:71], v[48:51], v[248:251]
  v_mfma_f32_16x16x32_bf16 v[156:159], v[56:59], v[52:55], v[156:159]
  v_mfma_f32_16x16x32_bf16 v[188:191], v[60:63], v[52:55], v[188:191]
  v_mfma_f32_16x16x32_bf16 v[220:223], v[64:67], v[52:55], v[220:223]
  v_mfma_f32_16x16x32_bf16 v[252:255], v[68:71], v[52:55], v[252:255]
L_done_8:
  s_add_u32 s25, s25, 2
  s_cmp_lt_u32 s25, s19
  s_cbranch_scc0 L_k1_epi
  s_barrier
  s_branch L_k1_g1loop
L_k1_epi:
  s_mul_i32 s27, s21, 16384
  v_and_b32 v17, 31, v1
  v_lshlrev_b32 v2, 7, v17
  v_add_u32 v2, s27, v2
  v_lshrrev_b32 v18, 5, v1
  v_and_b32 v19, 7, v1
  v_xor_b32 v18, v18, v19
  v_lshlrev_b32 v3, 4, v1
  v_add_u32 v3, s27, v3
  s_and_b32 s27, s21, 1
  s_mul_i32 s27, s27, 128
  s_lshr_b32 s28, s21, 1
  s_mul_i32 s28, s28, 128
  v_lshrrev_b32 v17, 3, v1
  v_xor_b32 v19, v19, v17
  v_add_u32 v17, s27, v17
  v_mul_lo_u32 v4, v17, s18
  v_lshl_add_u32 v4, v19, 4, v4
  v_add_u32 v4, s28, v4
  s_mul_i32 s27, s21, 16384
  v_and_b32 v17, 15, v1
  v_lshlrev_b32 v2, 7, v17
  v_add_u32 v2, s27, v2
  v_bfe_u32 v17, v1, 4, 1
  v_lshl_add_u32 v2, v17, 3, v2
  v_lshrrev_b32 v18, 5, v1
  v_and_b32 v19, 7, v1
  v_xor_b32 v18, v18, v19
  v_xor_b32 v17, 0, v18
  v_lshl_add_u32 v10, v17, 4, v2
  v_xor_b32 v17, 2, v18
  v_lshl_add_u32 v11, v17, 4, v2
  v_xor_b32 v17, 4, v18
  v_lshl_add_u32 v12, v17, 4, v2
  v_xor_b32 v17, 6, v18
  v_lshl_add_u32 v13, v17, 4, v2
  s_nop 7
  v_mul_f32 v128, s20, v128
  v_mul_f32 v129, s20, v129
  v_mul_f32 v130, s20, v130
  v_mul_f32 v131, s20, v131
  v_cvt_pk_bf16_f32 v24, v128, v129
  v_cvt_pk_bf16_f32 v25, v130, v131
  ds_write_b64 v10, v[24:25] offset:0
  v_mul_f32 v160, s20, v160
  v_mul_f32 v161, s20, v161
  v_mul_f32 v162, s20, v162
  v_mul_f32 v163, s20, v163
  v_cvt_pk_bf16_f32 v26, v160, v161
  v_cvt_pk_bf16_f32 v27, v162, v163
  ds_write_b64 v11, v[26:27] offset:0
  v_mul_f32 v192, s20, v192
  v_mul_f32 v193, s20, v193
  v_mul_f32 v194, s20, v194
  v_mul_f32 v195, s20, v195
  v_cvt_pk_bf16_f32 v28, v192, v193
  v_cvt_pk_bf16_f32 v29, v194, v195
  ds_write_b64 v12, v[28:29] offset:0
  v_mul_f32 v224, s20, v224
  v_mul_f32 v225, s20, v225
  v_mul_f32 v226, s20, v226
  v_mul_f32 v227, s20, v227
  v_cvt_pk_bf16_f32 v30, v224, v225
  v_cvt_pk_bf16_f32 v31, v226, v227
  ds_write_b64 v13, v[30:31] offset:0
  v_mul_f32 v132, s20, v132
  v_mul_f32 v133, s20, v133
  v_mul_f32 v134, s20, v134
  v_mul_f32 v135, s20, v135
  v_cvt_pk_bf16_f32 v32, v132, v133
  v_cvt_pk_bf16_f32 v33, v134, v135
  ds_write_b64 v10, v[32:33] offset:2048
  v_mul_f32 v164, s20, v164
  v_mul_f32 v165, s20, v165
  v_mul_f32 v166, s20, v166
  v_mul_f32 v167, s20, v167
  v_cvt_pk_bf16_f32 v34, v164, v165
  v_cvt_pk_bf16_f32 v35, v166, v167
  ds_write_b64 v11, v[34:35] offset:2048
  v_mul_f32 v196, s20, v196
  v_mul_f32 v197, s20, v197
  v_mul_f32 v198, s20, v198
  v_mul_f32 v199, s20, v199
  v_cvt_pk_bf16_f32 v36, v196, v197
  v_cvt_pk_bf16_f32 v37, v198, v199
  ds_write_b64 v12, v[36:37] offset:2048
  v_mul_f32 v228, s20, v228
  v_mul_f32 v229, s20, v229
  v_mul_f32 v230, s20, v230
  v_mul_f32 v231, s20, v231
  v_cvt_pk_bf16_f32 v38, v228, v229
  v_cvt_pk_bf16_f32 v39, v230, v231
  ds_write_b64 v13, v[38:39] offset:2048
  v_mul_f32 v136, s20, v136
  v_mul_f32 v137, s20, v137
  v_mul_f32 v138, s20, v138
  v_mul_f32 v139, s20, v139
  v_cvt_pk_bf16_f32 v24, v136, v137
  v_cvt_pk_bf16_f32 v25, v138, v139
  ds_write_b64 v10, v[24:25] offset:4096
  v_mul_f32 v168, s20, v168
  v_mul_f32 v169, s20, v169
  v_mul_f32 v170, s20, v170
  v_mul_f32 v171, s20, v171
  v_cvt_pk_bf16_f32 v26, v168, v169
  v_cvt_pk_bf16_f32 v27, v170, v171
  ds_write_b64 v11, v[26:27] offset:4096
  v_mul_f32 v200, s20, v200
  v_mul_f32 v201, s20, v201
  v_mul_f32 v202, s20, v202
  v_mul_f32 v203, s20, v203
  v_cvt_pk_bf16_f32 v28, v200, v201
  v_cvt_pk_bf16_f32 v29, v202, v203
  ds_write_b64 v12, v[28:29] offset:4096
  v_mul_f32 v232, s20, v232
  v_mul_f32 v233, s20, v233
  v_mul_f32 v234, s20, v234
  v_mul_f32 v235, s20, v235
  v_cvt_pk_bf16_f32 v30, v232, v233
  v_cvt_pk_bf16_f32 v31, v234, v235
  ds_write_b64 v13, v[30:31] offset:4096
  v_mul_f32 v140, s20, v140
  v_mul_f32 v141, s20, v141
  v_mul_f32 v142, s20, v142
  v_mul_f32 v143, s20, v143
  v_cvt_pk_bf16_f32 v32, v140, v141
  v_cvt_pk_bf16_f32 v33, v142, v143
  ds_write_b64 v10, v[32:33] offset:6144
  v_mul_f32 v172, s20, v172
  v_mul_f32 v173, s20, v173
  v_mul_f32 v174, s20, v174
  v_mul_f32 v175, s20, v175
  v_cvt_pk_bf16_f32 v34, v172, v173
  v_cvt_pk_bf16_f32 v35, v174, v175
  ds_write_b64 v11, v[34:35] offset:6144
  v_mul_f32 v204, s20, v204
  v_mul_f32 v205, s20, v205
  v_mul_f32 v206, s20, v206
  v_mul_f32 v207, s20, v207
  v_cvt_pk_bf16_f32 v36, v204, v205
  v_cvt_pk_bf16_f32 v37, v206, v207
  ds_write_b64 v12, v[36:37] offset:6144
  v_mul_f32 v236, s20, v236
  v_mul_f32 v237, s20, v237
  v_mul_f32 v238, s20, v238
  v_mul_f32 v239, s20, v239
  v_cvt_pk_bf16_f32 v38, v236, v237
  v_cvt_pk_bf16_f32 v39, v238, v239
  ds_write_b64 v13, v[38:39] offset:6144
  v_mul_f32 v144, s20, v144
  v_mul_f32 v145, s20, v145
  v_mul_f32 v146, s20, v146
  v_mul_f32 v147, s20, v147
  v_cvt_pk_bf16_f32 v24, v144, v145
  v_cvt_pk_bf16_f32 v25, v146, v147
  ds_write_b64 v10, v[24:25] offset:8192
  v_mul_f32 v176, s20, v176
  v_mul_f32 v177, s20, v177
  v_mul_f32 v178, s20, v178
  v_mul_f32 v179, s20, v179
  v_cvt_pk_bf16_f32 v26, v176, v177
  v_cvt_pk_bf16_f32 v27, v178, v179
  ds_write_b64 v11, v[26:27] offset:8192
  v_mul_f32 v208, s20, v208
  v_mul_f32 v209, s20, v209
  v_mul_f32 v210, s20, v210
  v_mul_f32 v211, s20, v211
  v_cvt_pk_bf16_f32 v28, v208, v209
  v_cvt_pk_bf16_f32 v29, v210, v211
  ds_write_b64 v12, v[28:29] offset:8192
  v_mul_f32 v240, s20, v240
  v_mul_f32 v241, s20, v241
  v_mul_f32 v242, s20, v242
  v_mul_f32 v243, s20, v243
  v_cvt_pk_bf16_f32 v30, v240, v241
  v_cvt_pk_bf16_f32 v31, v242, v243
  ds_write_b64 v13, v[30:31] offset:8192
  v_mul_f32 v148, s20, v148
  v_mul_f32 v149, s20, v149
  v_mul_f32 v150, s20, v150
  v_mul_f32 v151, s20, v151
  v_cvt_pk_bf16_f32 v32, v148, v149
  v_cvt_pk_bf16_f32 v33, v150, v151
  ds_write_b64 v10, v[32:33] offset:10240
  v_mul_f32 v180, s20, v180
  v_mul_f32 v181, s20, v181
  v_mul_f32 v182, s20, v182
  v_mul_f32 v183, s20, v183
  v_cvt_pk_bf16_f32 v34, v180, v181
  v_cvt_pk_bf16_f32 v35, v182, v183
  ds_write_b64 v11, v[34:35] offset:10240
  v_mul_f32 v212, s20, v212
  v_mul_f32 v213, s20, v213
  v_mul_f32 v214, s20, v214
  v_mul_f32 v215, s20, v215
  v_cvt_pk_bf16_f32 v36, v212, v213
  v_cvt_pk_bf16_f32 v37, v214, v215
  ds_write_b64 v12, v[36:37] offset:10240
  v_mul_f32 v244, s20, v244
  v_mul_f32 v245, s20, v245
  v_mul_f32 v246, s20, v246
  v_mul_f32 v247, s20, v247
  v_cvt_pk_bf16_f32 v38, v244, v245
  v_cvt_pk_bf16_f32 v39, v246, v247
  ds_write_b64 v13, v[38:39] offset:10240
  v_mul_f32 v152, s20, v152
  v_mul_f32 v153, s20, v153
  v_mul_f32 v154, s20, v154
  v_mul_f32 v155, s20, v155
  v_cvt_pk_bf16_f32 v24, v152, v153
  v_cvt_pk_bf16_f32 v25, v154, v155
  ds_write_b64 v10, v[24:25] offset:12288
  v_mul_f32 v184, s20, v184
  v_mul_f32 v185, s20, v185
  v_mul_f32 v186, s20, v186
  v_mul_f32 v187, s20, v187
  v_cvt_pk_bf16_f32 v26, v184, v185
  v_cvt_pk_bf16_f32 v27, v186, v187
  ds_write_b64 v11, v[26:27] offset:12288
  v_mul_f32 v216, s20, v216
  v_mul_f32 v217, s20, v217
  v_mul_f32 v218, s20, v218
  v_mul_f32 v219, s20, v219
  v_cvt_pk_bf16_f32 v28, v216, v217
  v_cvt_pk_bf16_f32 v29, v218, v219
  ds_write_b64 v12, v[28:29] offset:12288
  v_mul_f32 v248, s20, v248
  v_mul_f32 v249, s20, v249
  v_mul_f32 v250, s20, v250
  v_mul_f32 v251, s20, v251
  v_cvt_pk_bf16_f32 v30, v248, v249
  v_cvt_pk_bf16_f32 v31, v250, v251
  ds_write_b64 v13, v[30:31] offset:12288
  v_mul_f32 v156, s20, v156
  v_mul_f32 v157, s20, v157
  v_mul_f32 v158, s20, v158
  v_mul_f32 v159, s20, v159
  v_cvt_pk_bf16_f32 v32, v156, v157
  v_cvt_pk_bf16_f32 v33, v158, v159
  ds_write_b64 v10, v[32:33] offset:14336
  v_mul_f32 v188, s20, v188
  v_mul_f32 v189, s20, v189
  v_mul_f32 v190, s20, v190
  v_mul_f32 v191, s20, v191
  v_cvt_pk_bf16_f32 v34, v188, v189
  v_cvt_pk_bf16_f32 v35, v190, v191
  ds_write_b64 v11, v[34:35] offset:14336
  v_mul_f32 v220, s20, v220
  v_mul_f32 v221, s20, v221
  v_mul_f32 v222, s20, v222
  v_mul_f32 v223, s20, v223
  v_cvt_pk_bf16_f32 v36, v220, v221
  v_cvt_pk_bf16_f32 v37, v222, v223
  ds_write_b64 v12, v[36:37] offset:14336
  v_mul_f32 v252, s20, v252
  v_mul_f32 v253, s20, v253
  v_mul_f32 v254, s20, v254
  v_mul_f32 v255, s20, v255
  v_cvt_pk_bf16_f32 v38, v252, v253
  v_cvt_pk_bf16_f32 v39, v254, v255
  ds_write_b64 v13, v[38:39] offset:14336
  s_nop 7
  s_waitcnt lgkmcnt(0)
  ds_read_b128 v[128:131], v3 offset:0
  ds_read_b128 v[132:135], v3 offset:1024
  ds_read_b128 v[136:139], v3 offset:2048
  ds_read_b128 v[140:143], v3 offset:3072
  ds_read_b128 v[144:147], v3 offset:4096
  ds_read_b128 v[148:151], v3 offset:5120
  ds_read_b128 v[152:155], v3 offset:6144
  ds_read_b128 v[156:159], v3 offset:7168
  ds_read_b128 v[160:163], v3 offset:8192
  ds_read_b128 v[164:167], v3 offset:9216
  ds_read_b128 v[168:171], v3 offset:10240
  ds_read_b128 v[172:175], v3 offset:11264
  ds_read_b128 v[176:179], v3 offset:12288
  ds_read_b128 v[180:183], v3 offset:13312
  ds_read_b128 v[184:187], v3 offset:14336
  ds_read_b128 v[188:191], v3 offset:15360
  s_lshl_b32 s28, s18, 3
  s_mov_b32 s27, 0
  s_waitcnt lgkmcnt(15)
  buffer_store_dwordx4 v[128:131], v4, s[12:15], s27 offen
  s_add_u32 s27, s27, s28
  s_waitcnt lgkmcnt(14)
  buffer_store_dwordx4 v[132:135], v4, s[12:15], s27 offen
  s_add_u32 s27, s27, s28
  s_waitcnt lgkmcnt(13)
  buffer_store_dwordx4 v[136:139], v4, s[12:15], s27 offen
  s_add_u32 s27, s27, s28
  s_waitcnt lgkmcnt(12)
  buffer_store_dwordx4 v[140:143], v4, s[12:15], s27 offen
  s_add_u32 s27, s27, s28
  s_waitcnt lgkmcnt(11)
  buffer_store_dwordx4 v[144:147], v4, s[12:15], s27 offen
  s_add_u32 s27, s27, s28
  s_waitcnt lgkmcnt(10)
  buffer_store_dwordx4 v[148:151], v4, s[12:15], s27 offen
  s_add_u32 s27, s27, s28
  s_waitcnt lgkmcnt(9)
  buffer_store_dwordx4 v[152:155], v4, s[12:15], s27 offen
  s_add_u32 s27, s27, s28
  s_waitcnt lgkmcnt(8)
  buffer_store_dwordx4 v[156:159], v4, s[12:15], s27 offen
  s_add_u32 s27, s27, s28
  s_waitcnt lgkmcnt(7)
  buffer_store_dwordx4 v[160:163], v4, s[12:15], s27 offen
  s_add_u32 s27, s27, s28
  s_waitcnt lgkmcnt(6)
  buffer_store_dwordx4 v[164:167], v4, s[12:15], s27 offen
  s_add_u32 s27, s27, s28
  s_waitcnt lgkmcnt(5)
  buffer_store_dwordx4 v[168:171], v4, s[12:15], s27 offen
  s_add_u32 s27, s27, s28
  s_waitcnt lgkmcnt(4)
  buffer_store_dwordx4 v[172:175], v4, s[12:15], s27 offen
  s_add_u32 s27, s27, s28
  s_waitcnt lgkmcnt(3)
  buffer_store_dwordx4 v[176:179], v4, s[12:15], s27 offen
  s_add_u32 s27, s27, s28
  s_waitcnt lgkmcnt(2)
  buffer_store_dwordx4 v[180:183], v4, s[12:15], s27 offen
  s_add_u32 s27, s27, s28
  s_waitcnt lgkmcnt(1)
  buffer_store_dwordx4 v[184:187], v4, s[12:15], s27 offen
  s_add_u32 s27, s27, s28
  s_waitcnt lgkmcnt(0)
  buffer_store_dwordx4 v[188:191], v4, s[12:15], s27 offen
  s_branch L_k1_end
L_k1_qa:
  s_sub_u32 s60, s2, 384
  s_and_b32 s63, s60, 7
  s_lshr_b32 s60, s60, 3
  s_lshr_b32 s61, s63, 1
  s_lshl_b32 s61, s61, 2
  s_and_b32 s62, s60, 3
  s_add_u32 s61, s61, s62
  s_and_b32 s62, s63, 1
  s_lshl_b32 s62, s62, 2
  s_lshr_b32 s60, s60, 2
  s_add_u32 s62, s62, s60
  s_mul_i32 s63, s61, 262144
  s_add_u32 s4, s32, 0x0
  s_addc_u32 s5, s33, 0
  s_add_u32 s4, s4, s63
  s_addc_u32 s5, s5, 0
  s_sub_u32 s6, 0x400000, s63
  s_mov_b32 s7, 0x00020000
  s_mul_i32 s63, s62, 256
  s_add_u32 s8, s34, 0x0
  s_addc_u32 s9, s35, 0
  s_add_u32 s8, s8, s63
  s_addc_u32 s9, s9, 0
  s_sub_u32 s10, 0x200000, s63
  s_mov_b32 s11, 0x00020000
  s_mul_i32 s63, s61, 262144
  s_mul_i32 s60, s62, 256
  s_add_u32 s63, s63, s60
  s_add_u32 s12, s58, 0x0
  s_addc_u32 s13, s59, 0
  s_add_u32 s12, s12, s63
  s_addc_u32 s13, s13, 0
  s_sub_u32 s14, 0x400000, s63
  s_mov_b32 s15, 0x00020000
  s_mov_b32 s16, 2048
  s_mov_b32 s17, 2048
  s_mov_b32 s18, 2048
  s_mov_b32 s19, 16
  s_mov_b32 s20, 0x3e8293ee
  v_and_b32 v1, 63, v0
  v_lshrrev_b32 v17, 6, v0
  s_nop 0
  v_readfirstlane_b32 s21, v17
  s_nop 3
  s_lshl_b32 s26, s21, 10
  s_and_b32 s27, s21, 1
  s_lshl_b32 s28, s27, 2
  v_lshrrev_b32 v17, 4, v1
  v_or_b32 v17, s28, v17
  v_and_b32 v18, 7, v1
  v_xor_b32 v17, v17, v18
  v_lshlrev_b32 v17, 4, v17
  v_lshrrev_b32 v18, 3, v1
  s_lshl_b32 s28, s21, 3
  v_add_u32 v18, s28, v18
  v_add_u32 v19, 0, v18
  v_mul_lo_u32 v19, v19, s16
  v_add_u32 v2, v19, v17
  v_add_u32 v19, 64, v18
  v_mul_lo_u32 v19, v19, s16
  v_add_u32 v3, v19, v17
  v_lshrrev_b32 v17, 4, v1
  v_lshlrev_b32 v18, 2, v17
  v_and_b32 v19, 15, v1
  v_xor_b32 v18, v18, v19
  v_lshlrev_b32 v18, 4, v18
  s_lshl_b32 s28, s21, 2
  v_add_u32 v17, s28, v17
  v_add_u32 v19, 0, v17
  v_mul_lo_u32 v19, v19, s17
  v_add_u32 v6, v19, v18
  v_add_u32 v19, 32, v17
  v_mul_lo_u32 v19, v19, s17
  v_add_u32 v7, v19, v18
  s_and_b32 s27, s21, 1
  s_lshr_b32 s28, s21, 1
  s_and_b32 s28, s28, 1
  v_and_b32 v17, 31, v1
  s_mul_i32 s22, s27, 64
  v_add_u32 v17, s22, v17
  v_mul_lo_u32 v16, v17, s18
  v_lshlrev_b32 v17, 7, v17
  v_lshrrev_b32 v18, 5, v1
  v_bfe_u32 v19, v1, 1, 3
  v_xor_b32 v19, v19, v18
  v_xor_b32 v20, 0, v19
  v_lshl_add_u32 v10, v20, 4, v17
  v_xor_b32 v20, 2, v19
  v_lshl_add_u32 v11, v20, 4, v17
  v_xor_b32 v20, 4, v19
  v_lshl_add_u32 v12, v20, 4, v17
  v_xor_b32 v20, 6, v19
  v_lshl_add_u32 v13, v20, 4, v17
  s_mul_i32 s22, s28, 128
  v_lshl_add_u32 v16, v18, 4, v16
  v_add_u32 v16, s22, v16
  v_bfe_u32 v17, v1, 2, 2
  v_lshl_add_u32 v18, v18, 3, v17
  v_mul_u32_u24 v18, 256, v18
  v_and_b32 v19, 1, v1
  v_lshl_add_u32 v18, v19, 3, v18
  v_add_u32 v18, 0x10000, v18
  v_bfe_u32 v19, v1, 4, 1
  v_bfe_u32 v20, v1, 1, 1
  v_lshl_add_u32 v19, v19, 1, v20
  s_mul_i32 s22, s28, 8
  v_add_u32 v19, s22, v19
  v_lshlrev_b32 v17, 2, v17
  v_add_u32 v20, 0, v19
  v_xor_b32 v20, v20, v17
  v_lshl_add_u32 v14, v20, 4, v18
  v_add_u32 v20, 4, v19
  v_xor_b32 v20, v20, v17
  v_lshl_add_u32 v15, v20, 4, v18
  s_lshl_b32 s24, s17, 6
  s_mov_b32 s22, 0
  s_mov_b32 s23, 0
  s_and_b32 s27, s21, 3
  s_and_b32 s28, s62, 7
  s_lshl_b32 s28, s28, 4
  s_lshl_b32 s29, s27, 2
  s_add_u32 s28, s28, s29
  v_add_u32 v18, s28, v1
  v_mul_lo_u32 v18, v18, s16
  s_and_b32 s28, s61, 3
  s_lshl_b32 s28, s28, 5
  s_lshl_b32 s29, s27, 3
  s_add_u32 s28, s28, s29
  v_add_u32 v17, s28, v1
  v_lshrrev_b32 v19, 1, v17
  v_mul_lo_u32 v19, v19, s17
  v_and_b32 v20, 1, v17
  v_lshl_add_u32 v19, v20, 7, v19
  s_cmp_ge_u32 s21, 4
  s_cselect_b64 vcc, -1, 0
  v_cndmask_b32 v22, v18, v19, vcc
  s_cselect_b32 s28, 8, 4
  v_mov_b32 v18, 0x7f000000
  v_cmp_gt_u32 vcc, s28, v1
  s_nop 1
  v_cndmask_b32 v22, v18, v22, vcc
  v_add_u32 v88, 0x10000, v10
  v_add_u32 v89, 0x10000, v11
  v_add_u32 v90, 0x10000, v12
  v_add_u32 v91, 0x10000, v13
  v_add_u32 v92, 0x10000, v14
  v_add_u32 v93, 0x10000, v15
  s_add_u32 m0, s26, 0x0
  s_nop 0
  buffer_load_dwordx4 v2, s[4:7], s22 offen lds
  s_add_u32 m0, s26, 0x2000
  s_nop 0
  buffer_load_dwordx4 v3, s[4:7], s22 offen lds
  s_add_u32 m0, s26, 0x10000
  s_nop 0
  buffer_load_dwordx4 v6, s[8:11], s23 offen lds
  s_add_u32 m0, s26, 0x12000
  s_nop 0
  buffer_load_dwordx4 v7, s[8:11], s23 offen lds
  s_add_u32 s22, s22, 128
  s_add_u32 s23, s23, s24
  s_add_u32 m0, s26, 0x4000
  s_nop 0
  buffer_load_dwordx4 v2, s[4:7], s22 offen lds
  s_add_u32 m0, s26, 0x6000
  s_nop 0
  buffer_load_dwordx4 v3, s[4:7], s22 offen lds
  s_add_u32 m0, s26, 0x14000
  s_nop 0
  buffer_load_dwordx4 v6, s[8:11], s23 offen lds
  s_add_u32 m0, s26, 0x16000
  s_nop 0
  buffer_load_dwordx4 v7, s[8:11], s23 offen lds
  s_add_u32 s22, s22, 128
  s_add_u32 s23, s23, s24
  s_add_u32 m0, s26, 0x8000
  s_nop 0
  buffer_load_dwordx4 v2, s[4:7], s22 offen lds
  s_add_u32 m0, s26, 0xa000
  s_nop 0
  buffer_load_dwordx4 v3, s[4:7], s22 offen lds
  s_add_u32 m0, s26, 0x18000
  s_nop 0
  buffer_load_dwordx4 v6, s[8:11], s23 offen lds
  s_add_u32 m0, s26, 0x1a000
  s_nop 0
  buffer_load_dwordx4 v7, s[8:11], s23 offen lds
  s_add_u32 s22, s22, 128
  s_add_u32 s23, s23, s24
  v_mov_b32 v128, 0
  v_mov_b32 v129, 0
  v_mov_b32 v130, 0
  v_mov_b32 v131, 0
  v_mov_b32 v132, 0
  v_mov_b32 v133, 0
  v_mov_b32 v134, 0
  v_mov_b32 v135, 0
  v_mov_b32 v136, 0
  v_mov_b32 v137, 0
  v_mov_b32 v138, 0
  v_mov_b32 v139, 0
  v_mov_b32 v140, 0
  v_mov_b32 v141, 0
  v_mov_b32 v142, 0
  v_mov_b32 v143, 0
  v_mov_b32 v144, 0
  v_mov_b32 v145, 0
  v_mov_b32 v146, 0
  v_mov_b32 v147, 0
  v_mov_b32 v148, 0
  v_mov_b32 v149, 0
  v_mov_b32 v150, 0
  v_mov_b32 v151, 0
  v_mov_b32 v152, 0
  v_mov_b32 v153, 0
  v_mov_b32 v154, 0
  v_mov_b32 v155, 0
  v_mov_b32 v156, 0
  v_mov_b32 v157, 0
  v_mov_b32 v158, 0
  v_mov_b32 v159, 0
  v_mov_b32 v160, 0
  v_mov_b32 v161, 0
  v_mov_b32 v162, 0
  v_mov_b32 v163, 0
  v_mov_b32 v164, 0
  v_mov_b32 v165, 0
  v_mov_b32 v166, 0
  v_mov_b32 v167, 0
  v_mov_b32 v168, 0
  v_mov_b32 v169, 0
  v_mov_b32 v170, 0
  v_mov_b32 v171, 0
  v_mov_b32 v172, 0
  v_mov_b32 v173, 0
  v_mov_b32 v174, 0
  v_mov_b32 v175, 0
  v_mov_b32 v176, 0
  v_mov_b32 v177, 0
  v_mov_b32 v178, 0
  v_mov_b32 v179, 0
  v_mov_b32 v180, 0
  v_mov_b32 v181, 0
  v_mov_b32 v182, 0
  v_mov_b32 v183, 0
  v_mov_b32 v184, 0
  v_mov_b32 v185, 0
  v_mov_b32 v186, 0
  v_mov_b32 v187, 0
  v_mov_b32 v188, 0
  v_mov_b32 v189, 0
  v_mov_b32 v190, 0
  v_mov_b32 v191, 0
  s_mov_b32 s25, 0
  s_waitcnt vmcnt(8)
  s_barrier
  s_cmp_ge_u32 s21, 4
  s_cbranch_scc1 L_k1q_g1
L_k1q_g0loop:
  s_add_u32 s27, s25, 3
  s_cmp_lt_u32 s27, s19
  s_cbranch_scc0 L_n_9
  ds_read_b64_tr_b16 v[56:57], v14 offset:0
  ds_read_b64_tr_b16 v[58:59], v14 offset:1024
  ds_read_b64_tr_b16 v[60:61], v15 offset:0
  ds_read_b64_tr_b16 v[62:63], v15 offset:1024
  ds_read_b128 v[24:27], v10 offset:0
  ds_read_b128 v[28:31], v10 offset:4096
  ds_read_b64_tr_b16 v[64:65], v14 offset:4096
  ds_read_b64_tr_b16 v[66:67], v14 offset:5120
  ds_read_b64_tr_b16 v[68:69], v15 offset:4096
  ds_read_b64_tr_b16 v[70:71], v15 offset:5120
  ds_read_b128 v[32:35], v11 offset:0
  ds_read_b128 v[36:39], v11 offset:4096
  ds_read_b64_tr_b16 v[72:73], v14 offset:8192
  ds_read_b64_tr_b16 v[74:75], v14 offset:9216
  ds_read_b64_tr_b16 v[76:77], v15 offset:8192
  ds_read_b64_tr_b16 v[78:79], v15 offset:9216
  ds_read_b128 v[40:43], v12 offset:0
  ds_read_b128 v[44:47], v12 offset:4096
  ds_read_b64_tr_b16 v[80:81], v14 offset:12288
  ds_read_b64_tr_b16 v[82:83], v14 offset:13312
  ds_read_b64_tr_b16 v[84:85], v15 offset:12288
  ds_read_b64_tr_b16 v[86:87], v15 offset:13312
  ds_read_b128 v[48:51], v13 offset:0
  ds_read_b128 v[52:55], v13 offset:4096
  s_add_u32 m0, s26, 0xc000
  s_nop 0
  buffer_load_dwordx4 v2, s[4:7], s22 offen lds
  s_add_u32 m0, s26, 0xe000
  s_nop 0
  buffer_load_dwordx4 v3, s[4:7], s22 offen lds
  s_add_u32 m0, s26, 0x1c000
  s_nop 0
  buffer_load_dwordx4 v6, s[8:11], s23 offen lds
  s_add_u32 m0, s26, 0x1e000
  s_nop 0
  buffer_load_dwordx4 v7, s[8:11], s23 offen lds
  s_add_u32 s22, s22, 128
  s_add_u32 s23, s23, s24
  s_waitcnt vmcnt(8) lgkmcnt(0)
  s_branch L_d_10
L_n_9:
  ds_read_b64_tr_b16 v[56:57], v14 offset:0
  ds_read_b64_tr_b16 v[58:59], v14 offset:1024
  ds_read_b64_tr_b16 v[60:61], v15 offset:0
  ds_read_b64_tr_b16 v[62:63], v15 offset:1024
  ds_read_b128 v[24:27], v10 offset:0
  ds_read_b128 v[28:31], v10 offset:4096
  ds_read_b64_tr_b16 v[64:65], v14 offset:4096
  ds_read_b64_tr_b16 v[66:67], v14 offset:5120
  ds_read_b64_tr_b16 v[68:69], v15 offset:4096
  ds_read_b64_tr_b16 v[70:71], v15 offset:5120
  ds_read_b128 v[32:35], v11 offset:0
  ds_read_b128 v[36:39], v11 offset:4096
  ds_read_b64_tr_b16 v[72:73], v14 offset:8192
  ds_read_b64_tr_b16 v[74:75], v14 offset:9216
  ds_read_b64_tr_b16 v[76:77], v15 offset:8192
  ds_read_b64_tr_b16 v[78:79], v15 offset:9216
  ds_read_b128 v[40:43], v12 offset:0
  ds_read_b128 v[44:47], v12 offset:4096
  ds_read_b64_tr_b16 v[80:81], v14 offset:12288
  ds_read_b64_tr_b16 v[82:83], v14 offset:13312
  ds_read_b64_tr_b16 v[84:85], v15 offset:12288
  ds_read_b64_tr_b16 v[86:87], v15 offset:13312
  ds_read_b128 v[48:51], v13 offset:0
  ds_read_b128 v[52:55], v13 offset:4096
  s_waitcnt vmcnt(0) lgkmcnt(0)
L_d_10:
  s_barrier
  s_add_u32 s25, s25, 1
  s_add_u32 s27, s25, 3
  s_cmp_lt_u32 s27, s19
  s_cbranch_scc0 L_n_11
  v_mfma_f32_32x32x16_bf16 v[128:143], v[56:59], v[24:27], v[128:143]
  v_mfma_f32_32x32x16_bf16 v[160:175], v[60:63], v[24:27], v[160:175]
  s_add_u32 m0, s26, 0x0
  s_nop 0
  buffer_load_dwordx4 v2, s[4:7], s22 offen lds
  v_mfma_f32_32x32x16_bf16 v[144:159], v[56:59], v[28:31], v[144:159]
  v_mfma_f32_32x32x16_bf16 v[176:191], v[60:63], v[28:31], v[176:191]
  v_mfma_f32_32x32x16_bf16 v[128:143], v[64:67], v[32:35], v[128:143]
  v_mfma_f32_32x32x16_bf16 v[160:175], v[68:71], v[32:35], v[160:175]
  s_add_u32 m0, s26, 0x2000
  s_nop 0
  buffer_load_dwordx4 v3, s[4:7], s22 offen lds
  v_mfma_f32_32x32x16_bf16 v[144:159], v[64:67], v[36:39], v[144:159]
  v_mfma_f32_32x32x16_bf16 v[176:191], v[68:71], v[36:39], v[176:191]
  v_mfma_f32_32x32x16_bf16 v[128:143], v[72:75], v[40:43], v[128:143]
  v_mfma_f32_32x32x16_bf16 v[160:175], v[76:79], v[40:43], v[160:175]
  s_add_u32 m0, s26, 0x10000
  s_nop 0
  buffer_load_dwordx4 v6, s[8:11], s23 offen lds
  v_mfma_f32_32x32x16_bf16 v[144:159], v[72:75], v[44:47], v[144:159]
  v_mfma_f32_32x32x16_bf16 v[176:191], v[76:79], v[44:47], v[176:191]
  v_mfma_f32_32x32x16_bf16 v[128:143], v[80:83], v[48:51], v[128:143]
  v_mfma_f32_32x32x16_bf16 v[160:175], v[84:87], v[48:51], v[160:175]
  s_add_u32 m0, s26, 0x12000
  s_nop 0
  buffer_load_dwordx4 v7, s[8:11], s23 offen lds
  s_add_u32 s22, s22, 128
  s_add_u32 s23, s23, s24
  v_mfma_f32_32x32x16_bf16 v[144:159], v[80:83], v[52:55], v[144:159]
  v_mfma_f32_32x32x16_bf16 v[176:191], v[84:87], v[52:55], v[176:191]
  s_waitcnt vmcnt(8)
  s_branch L_d_12
L_n_11:
  v_mfma_f32_32x32x16_bf16 v[128:143], v[56:59], v[24:27], v[128:143]
  v_mfma_f32_32x32x16_bf16 v[160:175], v[60:63], v[24:27], v[160:175]
  v_mfma_f32_32x32x16_bf16 v[144:159], v[56:59], v[28:31], v[144:159]
  v_mfma_f32_32x32x16_bf16 v[176:191], v[60:63], v[28:31], v[176:191]
  v_mfma_f32_32x32x16_bf16 v[128:143], v[64:67], v[32:35], v[128:143]
  v_mfma_f32_32x32x16_bf16 v[160:175], v[68:71], v[32:35], v[160:175]
  v_mfma_f32_32x32x16_bf16 v[144:159], v[64:67], v[36:39], v[144:159]
  v_mfma_f32_32x32x16_bf16 v[176:191], v[68:71], v[36:39], v[176:191]
  v_mfma_f32_32x32x16_bf16 v[128:143], v[72:75], v[40:43], v[128:143]
  v_mfma_f32_32x32x16_bf16 v[160:175], v[76:79], v[40:43], v[160:175]
  v_mfma_f32_32x32x16_bf16 v[144:159], v[72:75], v[44:47], v[144:159]
  v_mfma_f32_32x32x16_bf16 v[176:191], v[76:79], v[44:47], v[176:191]
  v_mfma_f32_32x32x16_bf16 v[128:143], v[80:83], v[48:51], v[128:143]
  v_mfma_f32_32x32x16_bf16 v[160:175], v[84:87], v[48:51], v[160:175]
  v_mfma_f32_32x32x16_bf16 v[144:159], v[80:83], v[52:55], v[144:159]
  v_mfma_f32_32x32x16_bf16 v[176:191], v[84:87], v[52:55], v[176:191]
  s_waitcnt vmcnt(0)
L_d_12:
  s_barrier
  s_add_u32 s25, s25, 1
  s_cmp_ge_u32 s25, s19
  s_cbranch_scc1 L_k1q_g0end
  s_add_u32 s27, s25, 3
  s_cmp_lt_u32 s27, s19
  s_cbranch_scc0 L_n_13
  ds_read_b64_tr_b16 v[56:57], v14 offset:32768
  ds_read_b64_tr_b16 v[58:59], v14 offset:33792
  ds_read_b64_tr_b16 v[60:61], v15 offset:32768
  ds_read_b64_tr_b16 v[62:63], v15 offset:33792
  ds_read_b128 v[24:27], v10 offset:32768
  ds_read_b128 v[28:31], v10 offset:36864
  ds_read_b64_tr_b16 v[64:65], v14 offset:36864
  ds_read_b64_tr_b16 v[66:67], v14 offset:37888
  ds_read_b64_tr_b16 v[68:69], v15 offset:36864
  ds_read_b64_tr_b16 v[70:71], v15 offset:37888
  ds_read_b128 v[32:35], v11 offset:32768
  ds_read_b128 v[36:39], v11 offset:36864
  ds_read_b64_tr_b16 v[72:73], v14 offset:40960
  ds_read_b64_tr_b16 v[74:75], v14 offset:41984
  ds_read_b64_tr_b16 v[76:77], v15 offset:40960
  ds_read_b64_tr_b16 v[78:79], v15 offset:41984
  ds_read_b128 v[40:43], v12 offset:32768
  ds_read_b128 v[44:47], v12 offset:36864
  ds_read_b64_tr_b16 v[80:81], v14 offset:45056
  ds_read_b64_tr_b16 v[82:83], v14 offset:46080
  ds_read_b64_tr_b16 v[84:85], v15 offset:45056
  ds_read_b64_tr_b16 v[86:87], v15 offset:46080
  ds_read_b128 v[48:51], v13 offset:32768
  ds_read_b128 v[52:55], v13 offset:36864
  s_add_u32 m0, s26, 0x4000
  s_nop 0
  buffer_load_dwordx4 v2, s[4:7], s22 offen lds
  s_add_u32 m0, s26, 0x6000
  s_nop 0
  buffer_load_dwordx4 v3, s[4:7], s22 offen lds
  s_add_u32 m0, s26, 0x14000
  s_nop 0
  buffer_load_dwordx4 v6, s[8:11], s23 offen lds
  s_add_u32 m0, s26, 0x16000
  s_nop 0
  buffer_load_dwordx4 v7, s[8:11], s23 offen lds
  s_add_u32 s22, s22, 128
  s_add_u32 s23, s23, s24
  s_waitcnt vmcnt(8) lgkmcnt(0)
  s_branch L_d_14
L_n_13:
  ds_read_b64_tr_b16 v[56:57], v14 offset:32768
  ds_read_b64_tr_b16 v[58:59], v14 offset:33792
  ds_read_b64_tr_b16 v[60:61], v15 offset:32768
  ds_read_b64_tr_b16 v[62:63], v15 offset:33792
  ds_read_b128 v[24:27], v10 offset:32768
  ds_read_b128 v[28:31], v10 offset:36864
  ds_read_b64_tr_b16 v[64:65], v14 offset:36864
  ds_read_b64_tr_b16 v[66:67], v14 offset:37888
  ds_read_b64_tr_b16 v[68:69], v15 offset:36864
  ds_read_b64_tr_b16 v[70:71], v15 offset:37888
  ds_read_b128 v[32:35], v11 offset:32768
  ds_read_b128 v[36:39], v11 offset:36864
  ds_read_b64_tr_b16 v[72:73], v14 offset:40960
  ds_read_b64_tr_b16 v[74:75], v14 offset:41984
  ds_read_b64_tr_b16 v[76:77], v15 offset:40960
  ds_read_b64_tr_b16 v[78:79], v15 offset:41984
  ds_read_b128 v[40:43], v12 offset:32768
  ds_read_b128 v[44:47], v12 offset:36864
  ds_read_b64_tr_b16 v[80:81], v14 offset:45056
  ds_read_b64_tr_b16 v[82:83], v14 offset:46080
  ds_read_b64_tr_b16 v[84:85], v15 offset:45056
  ds_read_b64_tr_b16 v[86:87], v15 offset:46080
  ds_read_b128 v[48:51], v13 offset:32768
  ds_read_b128 v[52:55], v13 offset:36864
  s_waitcnt vmcnt(0) lgkmcnt(0)
L_d_14:
  s_barrier
  s_add_u32 s25, s25, 1
  s_add_u32 s27, s25, 3
  s_cmp_lt_u32 s27, s19
  s_cbranch_scc0 L_n_15
  v_mfma_f32_32x32x16_bf16 v[128:143], v[56:59], v[24:27], v[128:143]
  v_mfma_f32_32x32x16_bf16 v[160:175], v[60:63], v[24:27], v[160:175]
  s_add_u32 m0, s26, 0x8000
  s_nop 0
  buffer_load_dwordx4 v2, s[4:7], s22 offen lds
  v_mfma_f32_32x32x16_bf16 v[144:159], v[56:59], v[28:31], v[144:159]
  v_mfma_f32_32x32x16_bf16 v[176:191], v[60:63], v[28:31], v[176:191]
  v_mfma_f32_32x32x16_bf16 v[128:143], v[64:67], v[32:35], v[128:143]
  v_mfma_f32_32x32x16_bf16 v[160:175], v[68:71], v[32:35], v[160:175]
  s_add_u32 m0, s26, 0xa000
  s_nop 0
  buffer_load_dwordx4 v3, s[4:7], s22 offen lds
  v_mfma_f32_32x32x16_bf16 v[144:159], v[64:67], v[36:39], v[144:159]
  v_mfma_f32_32x32x16_bf16 v[176:191], v[68:71], v[36:39], v[176:191]
  v_mfma_f32_32x32x16_bf16 v[128:143], v[72:75], v[40:43], v[128:143]
  v_mfma_f32_32x32x16_bf16 v[160:175], v[76:79], v[40:43], v[160:175]
  s_add_u32 m0, s26, 0x18000
  s_nop 0
  buffer_load_dwordx4 v6, s[8:11], s23 offen lds
  v_mfma_f32_32x32x16_bf16 v[144:159], v[72:75], v[44:47], v[144:159]
  v_mfma_f32_32x32x16_bf16 v[176:191], v[76:79], v[44:47], v[176:191]
  v_mfma_f32_32x32x16_bf16 v[128:143], v[80:83], v[48:51], v[128:143]
  v_mfma_f32_32x32x16_bf16 v[160:175], v[84:87], v[48:51], v[160:175]
  s_add_u32 m0, s26, 0x1a000
  s_nop 0
  buffer_load_dwordx4 v7, s[8:11], s23 offen lds
  s_add_u32 s22, s22, 128
  s_add_u32 s23, s23, s24
  v_mfma_f32_32x32x16_bf16 v[144:159], v[80:83], v[52:55], v[144:159]
  v_mfma_f32_32x32x16_bf16 v[176:191], v[84:87], v[52:55], v[176:191]
  s_waitcnt vmcnt(8)
  s_branch L_d_16
L_n_15:
  v_mfma_f32_32x32x16_bf16 v[128:143], v[56:59], v[24:27], v[128:143]
  v_mfma_f32_32x32x16_bf16 v[160:175], v[60:63], v[24:27], v[160:175]
  v_mfma_f32_32x32x16_bf16 v[144:159], v[56:59], v[28:31], v[144:159]
  v_mfma_f32_32x32x16_bf16 v[176:191], v[60:63], v[28:31], v[176:191]
  v_mfma_f32_32x32x16_bf16 v[128:143], v[64:67], v[32:35], v[128:143]
  v_mfma_f32_32x32x16_bf16 v[160:175], v[68:71], v[32:35], v[160:175]
  v_mfma_f32_32x32x16_bf16 v[144:159], v[64:67], v[36:39], v[144:159]
  v_mfma_f32_32x32x16_bf16 v[176:191], v[68:71], v[36:39], v[176:191]
  v_mfma_f32_32x32x16_bf16 v[128:143], v[72:75], v[40:43], v[128:143]
  v_mfma_f32_32x32x16_bf16 v[160:175], v[76:79], v[40:43], v[160:175]
  v_mfma_f32_32x32x16_bf16 v[144:159], v[72:75], v[44:47], v[144:159]
  v_mfma_f32_32x32x16_bf16 v[176:191], v[76:79], v[44:47], v[176:191]
  v_mfma_f32_32x32x16_bf16 v[128:143], v[80:83], v[48:51], v[128:143]
  v_mfma_f32_32x32x16_bf16 v[160:175], v[84:87], v[48:51], v[160:175]
  v_mfma_f32_32x32x16_bf16 v[144:159], v[80:83], v[52:55], v[144:159]
  v_mfma_f32_32x32x16_bf16 v[176:191], v[84:87], v[52:55], v[176:191]
  s_waitcnt vmcnt(0)
L_d_16:
  s_barrier
  s_add_u32 s25, s25, 1
  s_cmp_ge_u32 s25, s19
  s_cbranch_scc1 L_k1q_g0end
  s_branch L_k1q_g0loop
L_k1q_g0end:
  s_barrier
  s_branch L_k1q_epi
L_k1q_g1:
  s_add_u32 m0, s26, 0xc000
  s_nop 0
  buffer_load_dwordx4 v2, s[4:7], s22 offen lds
  s_add_u32 m0, s26, 0xe000
  s_nop 0
  buffer_load_dwordx4 v3, s[4:7], s22 offen lds
  s_add_u32 m0, s26, 0x1c000
  s_nop 0
  buffer_load_dwordx4 v6, s[8:11], s23 offen lds
  s_add_u32 m0, s26, 0x1e000
  s_nop 0
  buffer_load_dwordx4 v7, s[8:11], s23 offen lds
  s_add_u32 s22, s22, 128
  s_add_u32 s23, s23, s24
  s_waitcnt vmcnt(8)
  s_barrier
  s_add_u32 s25, s25, 1
L_k1q_g1loop:
  s_add_u32 s27, s25, 3
  s_cmp_lt_u32 s27, s19
  s_cbranch_scc0 L_n_17
  ds_read_b64_tr_b16 v[56:57], v14 offset:16384
  ds_read_b64_tr_b16 v[58:59], v14 offset:17408
  ds_read_b64_tr_b16 v[60:61], v15 offset:16384
  ds_read_b64_tr_b16 v[62:63], v15 offset:17408
  ds_read_b128 v[24:27], v10 offset:16384
  ds_read_b128 v[28:31], v10 offset:20480
  ds_read_b64_tr_b16 v[64:65], v14 offset:20480
  ds_read_b64_tr_b16 v[66:67], v14 offset:21504
  ds_read_b64_tr_b16 v[68:69], v15 offset:20480
  ds_read_b64_tr_b16 v[70:71], v15 offset:21504
  ds_read_b128 v[32:35], v11 offset:16384
  ds_read_b128 v[36:39], v11 offset:20480
  ds_read_b64_tr_b16 v[72:73], v14 offset:24576
  ds_read_b64_tr_b16 v[74:75], v14 offset:25600
  ds_read_b64_tr_b16 v[76:77], v15 offset:24576
  ds_read_b64_tr_b16 v[78:79], v15 offset:25600
  ds_read_b128 v[40:43], v12 offset:16384
  ds_read_b128 v[44:47], v12 offset:20480
  ds_read_b64_tr_b16 v[80:81], v14 offset:28672
  ds_read_b64_tr_b16 v[82:83], v14 offset:29696
  ds_read_b64_tr_b16 v[84:85], v15 offset:28672
  ds_read_b64_tr_b16 v[86:87], v15 offset:29696
  ds_read_b128 v[48:51], v13 offset:16384
  ds_read_b128 v[52:55], v13 offset:20480
  s_add_u32 m0, s26, 0x0
  s_nop 0
  buffer_load_dwordx4 v2, s[4:7], s22 offen lds
  s_add_u32 m0, s26, 0x2000
  s_nop 0
  buffer_load_dwordx4 v3, s[4:7], s22 offen lds
  s_add_u32 m0, s26, 0x10000
  s_nop 0
  buffer_load_dwordx4 v6, s[8:11], s23 offen lds
  s_add_u32 m0, s26, 0x12000
  s_nop 0
  buffer_load_dwordx4 v7, s[8:11], s23 offen lds
  s_add_u32 s22, s22, 128
  s_add_u32 s23, s23, s24
  s_waitcnt vmcnt(8) lgkmcnt(0)
  s_branch L_d_18
L_n_17:
  ds_read_b64_tr_b16 v[56:57], v14 offset:16384
  ds_read_b64_tr_b16 v[58:59], v14 offset:17408
  ds_read_b64_tr_b16 v[60:61], v15 offset:16384
  ds_read_b64_tr_b16 v[62:63], v15 offset:17408
  ds_read_b128 v[24:27], v10 offset:16384
  ds_read_b128 v[28:31], v10 offset:20480
  ds_read_b64_tr_b16 v[64:65], v14 offset:20480
  ds_read_b64_tr_b16 v[66:67], v14 offset:21504
  ds_read_b64_tr_b16 v[68:69], v15 offset:20480
  ds_read_b64_tr_b16 v[70:71], v15 offset:21504
  ds_read_b128 v[32:35], v11 offset:16384
  ds_read_b128 v[36:39], v11 offset:20480
  ds_read_b64_tr_b16 v[72:73], v14 offset:24576
  ds_read_b64_tr_b16 v[74:75], v14 offset:25600
  ds_read_b64_tr_b16 v[76:77], v15 offset:24576
  ds_read_b64_tr_b16 v[78:79], v15 offset:25600
  ds_read_b128 v[40:43], v12 offset:16384
  ds_read_b128 v[44:47], v12 offset:20480
  ds_read_b64_tr_b16 v[80:81], v14 offset:28672
  ds_read_b64_tr_b16 v[82:83], v14 offset:29696
  ds_read_b64_tr_b16 v[84:85], v15 offset:28672
  ds_read_b64_tr_b16 v[86:87], v15 offset:29696
  ds_read_b128 v[48:51], v13 offset:16384
  ds_read_b128 v[52:55], v13 offset:20480
  s_waitcnt vmcnt(0) lgkmcnt(0)
L_d_18:
  s_barrier
  s_add_u32 s25, s25, 1
  s_add_u32 s27, s25, 3
  s_cmp_lt_u32 s27, s19
  s_cbranch_scc0 L_n_19
  v_mfma_f32_32x32x16_bf16 v[128:143], v[56:59], v[24:27], v[128:143]
  v_mfma_f32_32x32x16_bf16 v[160:175], v[60:63], v[24:27], v[160:175]
  s_add_u32 m0, s26, 0x4000
  s_nop 0
  buffer_load_dwordx4 v2, s[4:7], s22 offen lds
  v_mfma_f32_32x32x16_bf16 v[144:159], v[56:59], v[28:31], v[144:159]
  v_mfma_f32_32x32x16_bf16 v[176:191], v[60:63], v[28:31], v[176:191]
  v_mfma_f32_32x32x16_bf16 v[128:143], v[64:67], v[32:35], v[128:143]
  v_mfma_f32_32x32x16_bf16 v[160:175], v[68:71], v[32:35], v[160:175]
  s_add_u32 m0, s26, 0x6000
  s_nop 0
  buffer_load_dwordx4 v3, s[4:7], s22 offen lds
  v_mfma_f32_32x32x16_bf16 v[144:159], v[64:67], v[36:39], v[144:159]
  v_mfma_f32_32x32x16_bf16 v[176:191], v[68:71], v[36:39], v[176:191]
  v_mfma_f32_32x32x16_bf16 v[128:143], v[72:75], v[40:43], v[128:143]
  v_mfma_f32_32x32x16_bf16 v[160:175], v[76:79], v[40:43], v[160:175]
  s_add_u32 m0, s26, 0x14000
  s_nop 0
  buffer_load_dwordx4 v6, s[8:11], s23 offen lds
  v_mfma_f32_32x32x16_bf16 v[144:159], v[72:75], v[44:47], v[144:159]
  v_mfma_f32_32x32x16_bf16 v[176:191], v[76:79], v[44:47], v[176:191]
  v_mfma_f32_32x32x16_bf16 v[128:143], v[80:83], v[48:51], v[128:143]
  v_mfma_f32_32x32x16_bf16 v[160:175], v[84:87], v[48:51], v[160:175]
  s_add_u32 m0, s26, 0x16000
  s_nop 0
  buffer_load_dwordx4 v7, s[8:11], s23 offen lds
  s_add_u32 s22, s22, 128
  s_add_u32 s23, s23, s24
  v_mfma_f32_32x32x16_bf16 v[144:159], v[80:83], v[52:55], v[144:159]
  v_mfma_f32_32x32x16_bf16 v[176:191], v[84:87], v[52:55], v[176:191]
  s_waitcnt vmcnt(8)
  s_branch L_d_20
L_n_19:
  v_mfma_f32_32x32x16_bf16 v[128:143], v[56:59], v[24:27], v[128:143]
  v_mfma_f32_32x32x16_bf16 v[160:175], v[60:63], v[24:27], v[160:175]
  v_mfma_f32_32x32x16_bf16 v[144:159], v[56:59], v[28:31], v[144:159]
  v_mfma_f32_32x32x16_bf16 v[176:191], v[60:63], v[28:31], v[176:191]
  v_mfma_f32_32x32x16_bf16 v[128:143], v[64:67], v[32:35], v[128:143]
  v_mfma_f32_32x32x16_bf16 v[160:175], v[68:71], v[32:35], v[160:175]
  v_mfma_f32_32x32x16_bf16 v[144:159], v[64:67], v[36:39], v[144:159]
  v_mfma_f32_32x32x16_bf16 v[176:191], v[68:71], v[36:39], v[176:191]
  v_mfma_f32_32x32x16_bf16 v[128:143], v[72:75], v[40:43], v[128:143]
  v_mfma_f32_32x32x16_bf16 v[160:175], v[76:79], v[40:43], v[160:175]
  v_mfma_f32_32x32x16_bf16 v[144:159], v[72:75], v[44:47], v[144:159]
  v_mfma_f32_32x32x16_bf16 v[176:191], v[76:79], v[44:47], v[176:191]
  v_mfma_f32_32x32x16_bf16 v[128:143], v[80:83], v[48:51], v[128:143]
  v_mfma_f32_32x32x16_bf16 v[160:175], v[84:87], v[48:51], v[160:175]
  v_mfma_f32_32x32x16_bf16 v[144:159], v[80:83], v[52:55], v[144:159]
  v_mfma_f32_32x32x16_bf16 v[176:191], v[84:87], v[52:55], v[176:191]
  s_waitcnt vmcnt(0)
L_d_20:
  s_barrier
  s_add_u32 s25, s25, 1
  s_cmp_gt_u32 s25, s19
  s_cbranch_scc1 L_k1q_epi
  s_add_u32 s27, s25, 3
  s_cmp_lt_u32 s27, s19
  s_cbranch_scc0 L_n_21
  ds_read_b64_tr_b16 v[56:57], v14 offset:49152
  ds_read_b64_tr_b16 v[58:59], v14 offset:50176
  ds_read_b64_tr_b16 v[60:61], v15 offset:49152
  ds_read_b64_tr_b16 v[62:63], v15 offset:50176
  ds_read_b128 v[24:27], v10 offset:49152
  ds_read_b128 v[28:31], v10 offset:53248
  ds_read_b64_tr_b16 v[64:65], v14 offset:53248
  ds_read_b64_tr_b16 v[66:67], v14 offset:54272
  ds_read_b64_tr_b16 v[68:69], v15 offset:53248
  ds_read_b64_tr_b16 v[70:71], v15 offset:54272
  ds_read_b128 v[32:35], v11 offset:49152
  ds_read_b128 v[36:39], v11 offset:53248
  ds_read_b64_tr_b16 v[72:73], v14 offset:57344
  ds_read_b64_tr_b16 v[74:75], v14 offset:58368
  ds_read_b64_tr_b16 v[76:77], v15 offset:57344
  ds_read_b64_tr_b16 v[78:79], v15 offset:58368
  ds_read_b128 v[40:43], v12 offset:49152
  ds_read_b128 v[44:47], v12 offset:53248
  ds_read_b64_tr_b16 v[80:81], v14 offset:61440
  ds_read_b64_tr_b16 v[82:83], v14 offset:62464
  ds_read_b64_tr_b16 v[84:85], v15 offset:61440
  ds_read_b64_tr_b16 v[86:87], v15 offset:62464
  ds_read_b128 v[48:51], v13 offset:49152
  ds_read_b128 v[52:55], v13 offset:53248
  s_add_u32 m0, s26, 0x8000
  s_nop 0
  buffer_load_dwordx4 v2, s[4:7], s22 offen lds
  s_add_u32 m0, s26, 0xa000
  s_nop 0
  buffer_load_dwordx4 v3, s[4:7], s22 offen lds
  s_add_u32 m0, s26, 0x18000
  s_nop 0
  buffer_load_dwordx4 v6, s[8:11], s23 offen lds
  s_add_u32 m0, s26, 0x1a000
  s_nop 0
  buffer_load_dwordx4 v7, s[8:11], s23 offen lds
  s_add_u32 s22, s22, 128
  s_add_u32 s23, s23, s24
  s_waitcnt vmcnt(8) lgkmcnt(0)
  s_branch L_d_22
L_n_21:
  ds_read_b64_tr_b16 v[56:57], v14 offset:49152
  ds_read_b64_tr_b16 v[58:59], v14 offset:50176
  ds_read_b64_tr_b16 v[60:61], v15 offset:49152
  ds_read_b64_tr_b16 v[62:63], v15 offset:50176
  ds_read_b128 v[24:27], v10 offset:49152
  ds_read_b128 v[28:31], v10 offset:53248
  ds_read_b64_tr_b16 v[64:65], v14 offset:53248
  ds_read_b64_tr_b16 v[66:67], v14 offset:54272
  ds_read_b64_tr_b16 v[68:69], v15 offset:53248
  ds_read_b64_tr_b16 v[70:71], v15 offset:54272
  ds_read_b128 v[32:35], v11 offset:49152
  ds_read_b128 v[36:39], v11 offset:53248
  ds_read_b64_tr_b16 v[72:73], v14 offset:57344
  ds_read_b64_tr_b16 v[74:75], v14 offset:58368
  ds_read_b64_tr_b16 v[76:77], v15 offset:57344
  ds_read_b64_tr_b16 v[78:79], v15 offset:58368
  ds_read_b128 v[40:43], v12 offset:49152
  ds_read_b128 v[44:47], v12 offset:53248
  ds_read_b64_tr_b16 v[80:81], v14 offset:61440
  ds_read_b64_tr_b16 v[82:83], v14 offset:62464
  ds_read_b64_tr_b16 v[84:85], v15 offset:61440
  ds_read_b64_tr_b16 v[86:87], v15 offset:62464
  ds_read_b128 v[48:51], v13 offset:49152
  ds_read_b128 v[52:55], v13 offset:53248
  s_waitcnt vmcnt(0) lgkmcnt(0)
L_d_22:
  s_barrier
  s_add_u32 s25, s25, 1
  s_add_u32 s27, s25, 3
  s_cmp_lt_u32 s27, s19
  s_cbranch_scc0 L_n_23
  v_mfma_f32_32x32x16_bf16 v[128:143], v[56:59], v[24:27], v[128:143]
  v_mfma_f32_32x32x16_bf16 v[160:175], v[60:63], v[24:27], v[160:175]
  s_add_u32 m0, s26, 0xc000
  s_nop 0
  buffer_load_dwordx4 v2, s[4:7], s22 offen lds
  v_mfma_f32_32x32x16_bf16 v[144:159], v[56:59], v[28:31], v[144:159]
  v_mfma_f32_32x32x16_bf16 v[176:191], v[60:63], v[28:31], v[176:191]
  v_mfma_f32_32x32x16_bf16 v[128:143], v[64:67], v[32:35], v[128:143]
  v_mfma_f32_32x32x16_bf16 v[160:175], v[68:71], v[32:35], v[160:175]
  s_add_u32 m0, s26, 0xe000
  s_nop 0
  buffer_load_dwordx4 v3, s[4:7], s22 offen lds
  v_mfma_f32_32x32x16_bf16 v[144:159], v[64:67], v[36:39], v[144:159]
  v_mfma_f32_32x32x16_bf16 v[176:191], v[68:71], v[36:39], v[176:191]
  v_mfma_f32_32x32x16_bf16 v[128:143], v[72:75], v[40:43], v[128:143]
  v_mfma_f32_32x32x16_bf16 v[160:175], v[76:79], v[40:43], v[160:175]
  s_add_u32 m0, s26, 0x1c000
  s_nop 0
  buffer_load_dwordx4 v6, s[8:11], s23 offen lds
  v_mfma_f32_32x32x16_bf16 v[144:159], v[72:75], v[44:47], v[144:159]
  v_mfma_f32_32x32x16_bf16 v[176:191], v[76:79], v[44:47], v[176:191]
  v_mfma_f32_32x32x16_bf16 v[128:143], v[80:83], v[48:51], v[128:143]
  v_mfma_f32_32x32x16_bf16 v[160:175], v[84:87], v[48:51], v[160:175]
  s_add_u32 m0, s26, 0x1e000
  s_nop 0
  buffer_load_dwordx4 v7, s[8:11], s23 offen lds
  s_add_u32 s22, s22, 128
  s_add_u32 s23, s23, s24
  v_mfma_f32_32x32x16_bf16 v[144:159], v[80:83], v[52:55], v[144:159]
  v_mfma_f32_32x32x16_bf16 v[176:191], v[84:87], v[52:55], v[176:191]
  s_waitcnt vmcnt(8)
  s_branch L_d_24
L_n_23:
  v_mfma_f32_32x32x16_bf16 v[128:143], v[56:59], v[24:27], v[128:143]
  v_mfma_f32_32x32x16_bf16 v[160:175], v[60:63], v[24:27], v[160:175]
  v_mfma_f32_32x32x16_bf16 v[144:159], v[56:59], v[28:31], v[144:159]
  v_mfma_f32_32x32x16_bf16 v[176:191], v[60:63], v[28:31], v[176:191]
  v_mfma_f32_32x32x16_bf16 v[128:143], v[64:67], v[32:35], v[128:143]
  v_mfma_f32_32x32x16_bf16 v[160:175], v[68:71], v[32:35], v[160:175]
  v_mfma_f32_32x32x16_bf16 v[144:159], v[64:67], v[36:39], v[144:159]
  v_mfma_f32_32x32x16_bf16 v[176:191], v[68:71], v[36:39], v[176:191]
  v_mfma_f32_32x32x16_bf16 v[128:143], v[72:75], v[40:43], v[128:143]
  v_mfma_f32_32x32x16_bf16 v[160:175], v[76:79], v[40:43], v[160:175]
  v_mfma_f32_32x32x16_bf16 v[144:159], v[72:75], v[44:47], v[144:159]
  v_mfma_f32_32x32x16_bf16 v[176:191], v[76:79], v[44:47], v[176:191]
  v_mfma_f32_32x32x16_bf16 v[128:143], v[80:83], v[48:51], v[128:143]
  v_mfma_f32_32x32x16_bf16 v[160:175], v[84:87], v[48:51], v[160:175]
  v_mfma_f32_32x32x16_bf16 v[144:159], v[80:83], v[52:55], v[144:159]
  v_mfma_f32_32x32x16_bf16 v[176:191], v[84:87], v[52:55], v[176:191]
  s_waitcnt vmcnt(0)
L_d_24:
  s_barrier
  s_add_u32 s25, s25, 1
  s_cmp_gt_u32 s25, s19
  s_cbranch_scc1 L_k1q_epi
  s_branch L_k1q_g1loop
L_k1q_epi:
  s_lshl_b32 s27, s21, 13
  v_lshlrev_b32 v17, 4, v1
  v_add_u32 v18, s27, v17
  s_xor_b32 s27, s27, 0x8000
  v_add_u32 v19, s27, v17
  s_nop 7
  s_nop 3
  s_cmp_ge_u32 s21, 4
  s_cbranch_scc1 L_r1_25
  ds_write_b128 v18, v[160:163] offset:0
  ds_write_b128 v18, v[164:167] offset:1024
  ds_write_b128 v18, v[168:171] offset:2048
  ds_write_b128 v18, v[172:175] offset:3072
  ds_write_b128 v18, v[176:179] offset:4096
  ds_write_b128 v18, v[180:183] offset:5120
  ds_write_b128 v18, v[184:187] offset:6144
  ds_write_b128 v18, v[188:191] offset:7168
  v_mov_b32 v96, v128
  v_mov_b32 v97, v129
  v_mov_b32 v98, v130
  v_mov_b32 v99, v131
  v_mov_b32 v100, v132
  v_mov_b32 v101, v133
  v_mov_b32 v102, v134
  v_mov_b32 v103, v135
  v_mov_b32 v104, v136
  v_mov_b32 v105, v137
  v_mov_b32 v106, v138
  v_mov_b32 v107, v139
  v_mov_b32 v108, v140
  v_mov_b32 v109, v141
  v_mov_b32 v110, v142
  v_mov_b32 v111, v143
  v_mov_b32 v112, v144
  v_mov_b32 v113, v145
  v_mov_b32 v114, v146
  v_mov_b32 v115, v147
  v_mov_b32 v116, v148
  v_mov_b32 v117, v149
  v_mov_b32 v118, v150
  v_mov_b32 v119, v151
  v_mov_b32 v120, v152
  v_mov_b32 v121, v153
  v_mov_b32 v122, v154
  v_mov_b32 v123, v155
  v_mov_b32 v124, v156
  v_mov_b32 v125, v157
  v_mov_b32 v126, v158
  v_mov_b32 v127, v159
  s_branch L_r2_26
L_r1_25:
  ds_write_b128 v18, v[128:131] offset:0
  ds_write_b128 v18, v[132:135] offset:1024
  ds_write_b128 v18, v[136:139] offset:2048
  ds_write_b128 v18, v[140:143] offset:3072
  ds_write_b128 v18, v[144:147] offset:4096
  ds_write_b128 v18, v[148:151] offset:5120
  ds_write_b128 v18, v[152:155] offset:6144
  ds_write_b128 v18, v[156:159] offset:7168
  v_mov_b32 v96, v160
  v_mov_b32 v97, v161
  v_mov_b32 v98, v162
  v_mov_b32 v99, v163
  v_mov_b32 v100, v164
  v_mov_b32 v101, v165
  v_mov_b32 v102, v166
  v_mov_b32 v103, v167
  v_mov_b32 v104, v168
  v_mov_b32 v105, v169
  v_mov_b32 v106, v170
  v_mov_b32 v107, v171
  v_mov_b32 v108, v172
  v_mov_b32 v109, v173
  v_mov_b32 v110, v174
  v_mov_b32 v111, v175
  v_mov_b32 v112, v176
  v_mov_b32 v113, v177
  v_mov_b32 v114, v178
  v_mov_b32 v115, v179
  v_mov_b32 v116, v180
  v_mov_b32 v117, v181
  v_mov_b32 v118, v182
  v_mov_b32 v119, v183
  v_mov_b32 v120, v184
  v_mov_b32 v121, v185
  v_mov_b32 v122, v186
  v_mov_b32 v123, v187
  v_mov_b32 v124, v188
  v_mov_b32 v125, v189
  v_mov_b32 v126, v190
  v_mov_b32 v127, v191
L_r2_26:
  s_waitcnt lgkmcnt(0)
  s_barrier
  ds_read_b128 v[24:27], v19 offset:0
  ds_read_b128 v[28:31], v19 offset:1024
  ds_read_b128 v[32:35], v19 offset:2048
  ds_read_b128 v[36:39], v19 offset:3072
  ds_read_b128 v[40:43], v19 offset:4096
  ds_read_b128 v[44:47], v19 offset:5120
  ds_read_b128 v[48:51], v19 offset:6144
  ds_read_b128 v[52:55], v19 offset:7168
  s_waitcnt lgkmcnt(0)
  v_add_f32 v96, v96, v24
  v_add_f32 v97, v97, v25
  v_add_f32 v98, v98, v26
  v_add_f32 v99, v99, v27
  v_add_f32 v100, v100, v28
  v_add_f32 v101, v101, v29
  v_add_f32 v102, v102, v30
  v_add_f32 v103, v103, v31
  v_add_f32 v104, v104, v32
  v_add_f32 v105, v105, v33
  v_add_f32 v106, v106, v34
  v_add_f32 v107, v107, v35
  v_add_f32 v108, v108, v36
  v_add_f32 v109, v109, v37
  v_add_f32 v110, v110, v38
  v_add_f32 v111, v111, v39
  v_add_f32 v112, v112, v40
  v_add_f32 v113, v113, v41
  v_add_f32 v114, v114, v42
  v_add_f32 v115, v115, v43
  v_add_f32 v116, v116, v44
  v_add_f32 v117, v117, v45
  v_add_f32 v118, v118, v46
  v_add_f32 v119, v119, v47
  v_add_f32 v120, v120, v48
  v_add_f32 v121, v121, v49
  v_add_f32 v122, v122, v50
  v_add_f32 v123, v123, v51
  v_add_f32 v124, v124, v52
  v_add_f32 v125, v125, v53
  v_add_f32 v126, v126, v54
  v_add_f32 v127, v127, v55
  v_mul_f32 v96, s20, v96
  v_mul_f32 v97, s20, v97
  v_mul_f32 v98, s20, v98
  v_mul_f32 v99, s20, v99
  v_mul_f32 v100, s20, v100
  v_mul_f32 v101, s20, v101
  v_mul_f32 v102, s20, v102
  v_mul_f32 v103, s20, v103
  v_mul_f32 v104, s20, v104
  v_mul_f32 v105, s20, v105
  v_mul_f32 v106, s20, v106
  v_mul_f32 v107, s20, v107
  v_mul_f32 v108, s20, v108
  v_mul_f32 v109, s20, v109
  v_mul_f32 v110, s20, v110
  v_mul_f32 v111, s20, v111
  v_mul_f32 v112, s20, v112
  v_mul_f32 v113, s20, v113
  v_mul_f32 v114, s20, v114
  v_mul_f32 v115, s20, v115
  v_mul_f32 v116, s20, v116
  v_mul_f32 v117, s20, v117
  v_mul_f32 v118, s20, v118
  v_mul_f32 v119, s20, v119
  v_mul_f32 v120, s20, v120
  v_mul_f32 v121, s20, v121
  v_mul_f32 v122, s20, v122
  v_mul_f32 v123, s20, v123
  v_mul_f32 v124, s20, v124
  v_mul_f32 v125, s20, v125
  v_mul_f32 v126, s20, v126
  v_mul_f32 v127, s20, v127
  s_lshr_b32 s60, s21, 2
  s_lshl_b32 s60, s60, 6
  s_add_u32 s61, s60, 65536
  v_cvt_pk_bf16_f32 v56, v96, v97
  v_cvt_pk_bf16_f32 v57, v98, v99
  v_cvt_pk_bf16_f32 v58, v100, v101
  v_cvt_pk_bf16_f32 v59, v102, v103
  v_cvt_pk_bf16_f32 v60, v104, v105
  v_cvt_pk_bf16_f32 v61, v106, v107
  v_cvt_pk_bf16_f32 v62, v108, v109
  v_cvt_pk_bf16_f32 v63, v110, v111
  s_nop 1
  v_permlane32_swap_b32 v56, v58
  v_permlane32_swap_b32 v57, v59
  v_permlane32_swap_b32 v60, v62
  v_permlane32_swap_b32 v61, v63
  buffer_store_dwordx4 v[56:59], v16, s[12:15], s60 offen offset:0
  buffer_store_dwordx4 v[60:63], v16, s[12:15], s60 offen offset:32
  v_cvt_pk_bf16_f32 v56, v112, v113
  v_cvt_pk_bf16_f32 v57, v114, v115
  v_cvt_pk_bf16_f32 v58, v116, v117
  v_cvt_pk_bf16_f32 v59, v118, v119
  v_cvt_pk_bf16_f32 v60, v120, v121
  v_cvt_pk_bf16_f32 v61, v122, v123
  v_cvt_pk_bf16_f32 v62, v124, v125
  v_cvt_pk_bf16_f32 v63, v126, v127
  s_nop 1
  v_permlane32_swap_b32 v56, v58
  v_permlane32_swap_b32 v57, v59
  v_permlane32_swap_b32 v60, v62
  v_permlane32_swap_b32 v61, v63
  buffer_store_dwordx4 v[56:59], v16, s[12:15], s61 offen offset:0
  buffer_store_dwordx4 v[60:63], v16, s[12:15], s61 offen offset:32
  s_branch L_k1_end
L_k1_kva:
  v_and_b32 v1, 63, v0
  v_lshrrev_b32 v2, 6, v0
  s_nop 0
  v_readfirstlane_b32 s21, v2
  s_nop 3
  s_add_u32 s4, s32, 0x0
  s_addc_u32 s5, s33, 0
  s_mov_b32 s6, 0x400000
  s_mov_b32 s7, 0x00020000
  s_add_u32 s8, s36, 0x0
  s_addc_u32 s9, s37, 0
  s_mov_b32 s10, 0x10000
  s_mov_b32 s11, 0x00020000
  s_add_u32 s12, s38, 0x0
  s_addc_u32 s13, s39, 0
  s_mov_b32 s14, 0x10000
  s_mov_b32 s15, 0x00020000
  s_add_u32 s16, s58, 0x400000
  s_addc_u32 s17, s59, 0
  s_mov_b32 s18, 0x20000
  s_mov_b32 s19, 0x00020000
  s_add_u32 s64, s58, 0x440000
  s_addc_u32 s65, s59, 0
  s_mov_b32 s66, 0x20000
  s_mov_b32 s67, 0x00020000
  v_lshlrev_b32 v2, 4, v1
  s_lshl_b32 s22, s21, 13
  s_add_u32 s23, s22, 0
  s_mov_b32 m0, s23
  s_nop 0
  buffer_load_dwordx4 v2, s[8:11], s23 offen lds
  s_add_u32 m0, s23, 0x10000
  s_nop 0
  buffer_load_dwordx4 v2, s[12:15], s23 offen lds
  s_add_u32 s23, s22, 1024
  s_mov_b32 m0, s23
  s_nop 0
  buffer_load_dwordx4 v2, s[8:11], s23 offen lds
  s_add_u32 m0, s23, 0x10000
  s_nop 0
  buffer_load_dwordx4 v2, s[12:15], s23 offen lds
  s_add_u32 s23, s22, 2048
  s_mov_b32 m0, s23
  s_nop 0
  buffer_load_dwordx4 v2, s[8:11], s23 offen lds
  s_add_u32 m0, s23, 0x10000
  s_nop 0
  buffer_load_dwordx4 v2, s[12:15], s23 offen lds
  s_add_u32 s23, s22, 3072
  s_mov_b32 m0, s23
  s_nop 0
  buffer_load_dwordx4 v2, s[8:11], s23 offen lds
  s_add_u32 m0, s23, 0x10000
  s_nop 0
  buffer_load_dwordx4 v2, s[12:15], s23 offen lds
  s_add_u32 s23, s22, 4096
  s_mov_b32 m0, s23
  s_nop 0
  buffer_load_dwordx4 v2, s[8:11], s23 offen lds
  s_add_u32 m0, s23, 0x10000
  s_nop 0
  buffer_load_dwordx4 v2, s[12:15], s23 offen lds
  s_add_u32 s23, s22, 5120
  s_mov_b32 m0, s23
  s_nop 0
  buffer_load_dwordx4 v2, s[8:11], s23 offen lds
  s_add_u32 m0, s23, 0x10000
  s_nop 0
  buffer_load_dwordx4 v2, s[12:15], s23 offen lds
  s_add_u32 s23, s22, 6144
  s_mov_b32 m0, s23
  s_nop 0
  buffer_load_dwordx4 v2, s[8:11], s23 offen lds
  s_add_u32 m0, s23, 0x10000
  s_nop 0
  buffer_load_dwordx4 v2, s[12:15], s23 offen lds
  s_add_u32 s23, s22, 7168
  s_mov_b32 m0, s23
  s_nop 0
  buffer_load_dwordx4 v2, s[8:11], s23 offen lds
  s_add_u32 m0, s23, 0x10000
  s_nop 0
  buffer_load_dwordx4 v2, s[12:15], s23 offen lds
  s_sub_u32 s23, s2, 512
  s_lshl_b32 s23, s23, 5
  s_mov_b32 s25, s21
  v_and_b32 v3, 31, v1
  v_add_u32 v3, s23, v3
  v_lshrrev_b32 v4, 5, v1
  v_lshlrev_b32 v5, 11, v3
  v_lshl_add_u32 v5, v4, 4, v5
  s_lshl_b32 s26, s25, 8
  v_lshlrev_b32 v6, 6, v3
  v_lshl_add_u32 v6, v4, 4, v6
  v_bfe_u32 v7, v1, 2, 2
  v_lshl_add_u32 v7, v4, 3, v7
  v_lshlrev_b32 v7, 6, v7
  v_bfe_u32 v8, v1, 4, 1
  v_lshl_add_u32 v7, v8, 5, v7
  v_and_b32 v8, 3, v1
  v_lshl_add_u32 v7, v8, 3, v7
  s_lshl_b32 s27, s25, 13
  v_add_u32 v7, s27, v7
  v_add_u32 v8, 0x10000, v7
  buffer_load_dwordx4 v[64:67], v5, s[4:7], s26 offen offset:0
  buffer_load_dwordx4 v[68:71], v5, s[4:7], s26 offen offset:32
  buffer_load_dwordx4 v[72:75], v5, s[4:7], s26 offen offset:64
  buffer_load_dwordx4 v[76:79], v5, s[4:7], s26 offen offset:96
  buffer_load_dwordx4 v[80:83], v5, s[4:7], s26 offen offset:128
  buffer_load_dwordx4 v[84:87], v5, s[4:7], s26 offen offset:160
  buffer_load_dwordx4 v[88:91], v5, s[4:7], s26 offen offset:192
  buffer_load_dwordx4 v[92:95], v5, s[4:7], s26 offen offset:224
  s_waitcnt vmcnt(8)
  ds_read_b64_tr_b16 v[128:129], v7 offset:0
  ds_read_b64_tr_b16 v[130:131], v7 offset:256
  ds_read_b64_tr_b16 v[132:133], v8 offset:0
  ds_read_b64_tr_b16 v[134:135], v8 offset:256
  ds_read_b64_tr_b16 v[136:137], v7 offset:1024
  ds_read_b64_tr_b16 v[138:139], v7 offset:1280
  ds_read_b64_tr_b16 v[140:141], v8 offset:1024
  ds_read_b64_tr_b16 v[142:143], v8 offset:1280
  ds_read_b64_tr_b16 v[144:145], v7 offset:2048
  ds_read_b64_tr_b16 v[146:147], v7 offset:2304
  ds_read_b64_tr_b16 v[148:149], v8 offset:2048
  ds_read_b64_tr_b16 v[150:151], v8 offset:2304
  s_waitcnt lgkmcnt(4)
  ds_read_b64_tr_b16 v[152:153], v7 offset:3072
  ds_read_b64_tr_b16 v[154:155], v7 offset:3328
  ds_read_b64_tr_b16 v[156:157], v8 offset:3072
  ds_read_b64_tr_b16 v[158:159], v8 offset:3328
  ds_read_b64_tr_b16 v[160:161], v7 offset:4096
  ds_read_b64_tr_b16 v[162:163], v7 offset:4352
  ds_read_b64_tr_b16 v[164:165], v8 offset:4096
  ds_read_b64_tr_b16 v[166:167], v8 offset:4352
  ds_read_b64_tr_b16 v[168:169], v7 offset:5120
  ds_read_b64_tr_b16 v[170:171], v7 offset:5376
  ds_read_b64_tr_b16 v[172:173], v8 offset:5120
  ds_read_b64_tr_b16 v[174:175], v8 offset:5376
  s_waitcnt lgkmcnt(4)
  ds_read_b64_tr_b16 v[176:177], v7 offset:6144
  ds_read_b64_tr_b16 v[178:179], v7 offset:6400
  ds_read_b64_tr_b16 v[180:181], v8 offset:6144
  ds_read_b64_tr_b16 v[182:183], v8 offset:6400
  ds_read_b64_tr_b16 v[184:185], v7 offset:7168
  ds_read_b64_tr_b16 v[186:187], v7 offset:7424
  ds_read_b64_tr_b16 v[188:189], v8 offset:7168
  ds_read_b64_tr_b16 v[190:191], v8 offset:7424
  s_waitcnt vmcnt(0) lgkmcnt(0)
  v_mfma_f32_32x32x16_bf16 v[16:31], v[128:131], v[64:67], 0
  v_mfma_f32_32x32x16_bf16 v[32:47], v[64:67], v[132:135], 0
  v_mfma_f32_32x32x16_bf16 v[16:31], v[136:139], v[68:71], v[16:31]
  v_mfma_f32_32x32x16_bf16 v[32:47], v[68:71], v[140:143], v[32:47]
  v_mfma_f32_32x32x16_bf16 v[16:31], v[144:147], v[72:75], v[16:31]
  v_mfma_f32_32x32x16_bf16 v[32:47], v[72:75], v[148:151], v[32:47]
  v_mfma_f32_32x32x16_bf16 v[16:31], v[152:155], v[76:79], v[16:31]
  v_mfma_f32_32x32x16_bf16 v[32:47], v[76:79], v[156:159], v[32:47]
  v_mfma_f32_32x32x16_bf16 v[16:31], v[160:163], v[80:83], v[16:31]
  v_mfma_f32_32x32x16_bf16 v[32:47], v[80:83], v[164:167], v[32:47]
  v_mfma_f32_32x32x16_bf16 v[16:31], v[168:171], v[84:87], v[16:31]
  v_mfma_f32_32x32x16_bf16 v[32:47], v[84:87], v[172:175], v[32:47]
  v_mfma_f32_32x32x16_bf16 v[16:31], v[176:179], v[88:91], v[16:31]
  v_mfma_f32_32x32x16_bf16 v[32:47], v[88:91], v[180:183], v[32:47]
  v_mfma_f32_32x32x16_bf16 v[16:31], v[184:187], v[92:95], v[16:31]
  v_mfma_f32_32x32x16_bf16 v[32:47], v[92:95], v[188:191], v[32:47]
  s_nop 15
  s_nop 3
  v_add_u32 v9, s22, v2
  ds_write_b128 v9, v[16:19] offset:0
  ds_write_b128 v9, v[20:23] offset:1024
  ds_write_b128 v9, v[24:27] offset:2048
  ds_write_b128 v9, v[28:31] offset:3072
  ds_write_b128 v9, v[32:35] offset:4096
  ds_write_b128 v9, v[36:39] offset:5120
  ds_write_b128 v9, v[40:43] offset:6144
  ds_write_b128 v9, v[44:47] offset:7168
  s_waitcnt lgkmcnt(0)
  s_barrier
  s_cmp_eq_u32 s25, 0
  s_cbranch_scc0 L_k1_end
  ds_read_b128 v[64:67], v9 offset:8192
  ds_read_b128 v[68:71], v9 offset:9216
  ds_read_b128 v[72:75], v9 offset:10240
  ds_read_b128 v[76:79], v9 offset:11264
  ds_read_b128 v[80:83], v9 offset:12288
  ds_read_b128 v[84:87], v9 offset:13312
  ds_read_b128 v[88:91], v9 offset:14336
  ds_read_b128 v[92:95], v9 offset:15360
  ds_read_b128 v[96:99], v9 offset:16384
  ds_read_b128 v[100:103], v9 offset:17408
  ds_read_b128 v[104:107], v9 offset:18432
  ds_read_b128 v[108:111], v9 offset:19456
  ds_read_b128 v[112:115], v9 offset:20480
  ds_read_b128 v[116:119], v9 offset:21504
  ds_read_b128 v[120:123], v9 offset:22528
  ds_read_b128 v[124:127], v9 offset:23552
  ds_read_b128 v[128:131], v9 offset:24576
  ds_read_b128 v[132:135], v9 offset:25600
  ds_read_b128 v[136:139], v9 offset:26624
  ds_read_b128 v[140:143], v9 offset:27648
  ds_read_b128 v[144:147], v9 offset:28672
  ds_read_b128 v[148:151], v9 offset:29696
  ds_read_b128 v[152:155], v9 offset:30720
  ds_read_b128 v[156:159], v9 offset:31744
  ds_read_b128 v[160:163], v9 offset:32768
  ds_read_b128 v[164:167], v9 offset:33792
  ds_read_b128 v[168:171], v9 offset:34816
  ds_read_b128 v[172:175], v9 offset:35840
  ds_read_b128 v[176:179], v9 offset:36864
  ds_read_b128 v[180:183], v9 offset:37888
  ds_read_b128 v[184:187], v9 offset:38912
  ds_read_b128 v[188:191], v9 offset:39936
  s_waitcnt lgkmcnt(0)
  v_add_f32 v16, v16, v64
  v_add_f32 v17, v17, v65
  v_add_f32 v18, v18, v66
  v_add_f32 v19, v19, v67
  v_add_f32 v20, v20, v68
  v_add_f32 v21, v21, v69
  v_add_f32 v22, v22, v70
  v_add_f32 v23, v23, v71
  v_add_f32 v24, v24, v72
  v_add_f32 v25, v25, v73
  v_add_f32 v26, v26, v74
  v_add_f32 v27, v27, v75
  v_add_f32 v28, v28, v76
  v_add_f32 v29, v29, v77
  v_add_f32 v30, v30, v78
  v_add_f32 v31, v31, v79
  v_add_f32 v32, v32, v80
  v_add_f32 v33, v33, v81
  v_add_f32 v34, v34, v82
  v_add_f32 v35, v35, v83
  v_add_f32 v36, v36, v84
  v_add_f32 v37, v37, v85
  v_add_f32 v38, v38, v86
  v_add_f32 v39, v39, v87
  v_add_f32 v40, v40, v88
  v_add_f32 v41, v41, v89
  v_add_f32 v42, v42, v90
  v_add_f32 v43, v43, v91
  v_add_f32 v44, v44, v92
  v_add_f32 v45, v45, v93
  v_add_f32 v46, v46, v94
  v_add_f32 v47, v47, v95
  v_add_f32 v16, v16, v96
  v_add_f32 v17, v17, v97
  v_add_f32 v18, v18, v98
  v_add_f32 v19, v19, v99
  v_add_f32 v20, v20, v100
  v_add_f32 v21, v21, v101
  v_add_f32 v22, v22, v102
  v_add_f32 v23, v23, v103
  v_add_f32 v24, v24, v104
  v_add_f32 v25, v25, v105
  v_add_f32 v26, v26, v106
  v_add_f32 v27, v27, v107
  v_add_f32 v28, v28, v108
  v_add_f32 v29, v29, v109
  v_add_f32 v30, v30, v110
  v_add_f32 v31, v31, v111
  v_add_f32 v32, v32, v112
  v_add_f32 v33, v33, v113
  v_add_f32 v34, v34, v114
  v_add_f32 v35, v35, v115
  v_add_f32 v36, v36, v116
  v_add_f32 v37, v37, v117
  v_add_f32 v38, v38, v118
  v_add_f32 v39, v39, v119
  v_add_f32 v40, v40, v120
  v_add_f32 v41, v41, v121
  v_add_f32 v42, v42, v122
  v_add_f32 v43, v43, v123
  v_add_f32 v44, v44, v124
  v_add_f32 v45, v45, v125
  v_add_f32 v46, v46, v126
  v_add_f32 v47, v47, v127
  v_add_f32 v16, v16, v128
  v_add_f32 v17, v17, v129
  v_add_f32 v18, v18, v130
  v_add_f32 v19, v19, v131
  v_add_f32 v20, v20, v132
  v_add_f32 v21, v21, v133
  v_add_f32 v22, v22, v134
  v_add_f32 v23, v23, v135
  v_add_f32 v24, v24, v136
  v_add_f32 v25, v25, v137
  v_add_f32 v26, v26, v138
  v_add_f32 v27, v27, v139
  v_add_f32 v28, v28, v140
  v_add_f32 v29, v29, v141
  v_add_f32 v30, v30, v142
  v_add_f32 v31, v31, v143
  v_add_f32 v32, v32, v144
  v_add_f32 v33, v33, v145
  v_add_f32 v34, v34, v146
  v_add_f32 v35, v35, v147
  v_add_f32 v36, v36, v148
  v_add_f32 v37, v37, v149
  v_add_f32 v38, v38, v150
  v_add_f32 v39, v39, v151
  v_add_f32 v40, v40, v152
  v_add_f32 v41, v41, v153
  v_add_f32 v42, v42, v154
  v_add_f32 v43, v43, v155
  v_add_f32 v44, v44, v156
  v_add_f32 v45, v45, v157
  v_add_f32 v46, v46, v158
  v_add_f32 v47, v47, v159
  v_add_f32 v16, v16, v160
  v_add_f32 v17, v17, v161
  v_add_f32 v18, v18, v162
  v_add_f32 v19, v19, v163
  v_add_f32 v20, v20, v164
  v_add_f32 v21, v21, v165
  v_add_f32 v22, v22, v166
  v_add_f32 v23, v23, v167
  v_add_f32 v24, v24, v168
  v_add_f32 v25, v25, v169
  v_add_f32 v26, v26, v170
  v_add_f32 v27, v27, v171
  v_add_f32 v28, v28, v172
  v_add_f32 v29, v29, v173
  v_add_f32 v30, v30, v174
  v_add_f32 v31, v31, v175
  v_add_f32 v32, v32, v176
  v_add_f32 v33, v33, v177
  v_add_f32 v34, v34, v178
  v_add_f32 v35, v35, v179
  v_add_f32 v36, v36, v180
  v_add_f32 v37, v37, v181
  v_add_f32 v38, v38, v182
  v_add_f32 v39, v39, v183
  v_add_f32 v40, v40, v184
  v_add_f32 v41, v41, v185
  v_add_f32 v42, v42, v186
  v_add_f32 v43, v43, v187
  v_add_f32 v44, v44, v188
  v_add_f32 v45, v45, v189
  v_add_f32 v46, v46, v190
  v_add_f32 v47, v47, v191
  ds_read_b128 v[64:67], v9 offset:40960
  ds_read_b128 v[68:71], v9 offset:41984
  ds_read_b128 v[72:75], v9 offset:43008
  ds_read_b128 v[76:79], v9 offset:44032
  ds_read_b128 v[80:83], v9 offset:45056
  ds_read_b128 v[84:87], v9 offset:46080
  ds_read_b128 v[88:91], v9 offset:47104
  ds_read_b128 v[92:95], v9 offset:48128
  ds_read_b128 v[96:99], v9 offset:49152
  ds_read_b128 v[100:103], v9 offset:50176
  ds_read_b128 v[104:107], v9 offset:51200
  ds_read_b128 v[108:111], v9 offset:52224
  ds_read_b128 v[112:115], v9 offset:53248
  ds_read_b128 v[116:119], v9 offset:54272
  ds_read_b128 v[120:123], v9 offset:55296
  ds_read_b128 v[124:127], v9 offset:56320
  ds_read_b128 v[128:131], v9 offset:57344
  ds_read_b128 v[132:135], v9 offset:58368
  ds_read_b128 v[136:139], v9 offset:59392
  ds_read_b128 v[140:143], v9 offset:60416
  ds_read_b128 v[144:147], v9 offset:61440
  ds_read_b128 v[148:151], v9 offset:62464
  ds_read_b128 v[152:155], v9 offset:63488
  ds_read_b128 v[156:159], v9 offset:64512
  s_waitcnt lgkmcnt(0)
  v_add_f32 v16, v16, v64
  v_add_f32 v17, v17, v65
  v_add_f32 v18, v18, v66
  v_add_f32 v19, v19, v67
  v_add_f32 v20, v20, v68
  v_add_f32 v21, v21, v69
  v_add_f32 v22, v22, v70
  v_add_f32 v23, v23, v71
  v_add_f32 v24, v24, v72
  v_add_f32 v25, v25, v73
  v_add_f32 v26, v26, v74
  v_add_f32 v27, v27, v75
  v_add_f32 v28, v28, v76
  v_add_f32 v29, v29, v77
  v_add_f32 v30, v30, v78
  v_add_f32 v31, v31, v79
  v_add_f32 v32, v32, v80
  v_add_f32 v33, v33, v81
  v_add_f32 v34, v34, v82
  v_add_f32 v35, v35, v83
  v_add_f32 v36, v36, v84
  v_add_f32 v37, v37, v85
  v_add_f32 v38, v38, v86
  v_add_f32 v39, v39, v87
  v_add_f32 v40, v40, v88
  v_add_f32 v41, v41, v89
  v_add_f32 v42, v42, v90
  v_add_f32 v43, v43, v91
  v_add_f32 v44, v44, v92
  v_add_f32 v45, v45, v93
  v_add_f32 v46, v46, v94
  v_add_f32 v47, v47, v95
  v_add_f32 v16, v16, v96
  v_add_f32 v17, v17, v97
  v_add_f32 v18, v18, v98
  v_add_f32 v19, v19, v99
  v_add_f32 v20, v20, v100
  v_add_f32 v21, v21, v101
  v_add_f32 v22, v22, v102
  v_add_f32 v23, v23, v103
  v_add_f32 v24, v24, v104
  v_add_f32 v25, v25, v105
  v_add_f32 v26, v26, v106
  v_add_f32 v27, v27, v107
  v_add_f32 v28, v28, v108
  v_add_f32 v29, v29, v109
  v_add_f32 v30, v30, v110
  v_add_f32 v31, v31, v111
  v_add_f32 v32, v32, v112
  v_add_f32 v33, v33, v113
  v_add_f32 v34, v34, v114
  v_add_f32 v35, v35, v115
  v_add_f32 v36, v36, v116
  v_add_f32 v37, v37, v117
  v_add_f32 v38, v38, v118
  v_add_f32 v39, v39, v119
  v_add_f32 v40, v40, v120
  v_add_f32 v41, v41, v121
  v_add_f32 v42, v42, v122
  v_add_f32 v43, v43, v123
  v_add_f32 v44, v44, v124
  v_add_f32 v45, v45, v125
  v_add_f32 v46, v46, v126
  v_add_f32 v47, v47, v127
  v_add_f32 v16, v16, v128
  v_add_f32 v17, v17, v129
  v_add_f32 v18, v18, v130
  v_add_f32 v19, v19, v131
  v_add_f32 v20, v20, v132
  v_add_f32 v21, v21, v133
  v_add_f32 v22, v22, v134
  v_add_f32 v23, v23, v135
  v_add_f32 v24, v24, v136
  v_add_f32 v25, v25, v137
  v_add_f32 v26, v26, v138
  v_add_f32 v27, v27, v139
  v_add_f32 v28, v28, v140
  v_add_f32 v29, v29, v141
  v_add_f32 v30, v30, v142
  v_add_f32 v31, v31, v143
  v_add_f32 v32, v32, v144
  v_add_f32 v33, v33, v145
  v_add_f32 v34, v34, v146
  v_add_f32 v35, v35, v147
  v_add_f32 v36, v36, v148
  v_add_f32 v37, v37, v149
  v_add_f32 v38, v38, v150
  v_add_f32 v39, v39, v151
  v_add_f32 v40, v40, v152
  v_add_f32 v41, v41, v153
  v_add_f32 v42, v42, v154
  v_add_f32 v43, v43, v155
  v_add_f32 v44, v44, v156
  v_add_f32 v45, v45, v157
  v_add_f32 v46, v46, v158
  v_add_f32 v47, v47, v159
  v_cvt_pk_bf16_f32 v48, v16, v17
  v_cvt_pk_bf16_f32 v49, v18, v19
  v_cvt_pk_bf16_f32 v50, v20, v21
  v_cvt_pk_bf16_f32 v51, v22, v23
  v_cvt_pk_bf16_f32 v52, v24, v25
  v_cvt_pk_bf16_f32 v53, v26, v27
  v_cvt_pk_bf16_f32 v54, v28, v29
  v_cvt_pk_bf16_f32 v55, v30, v31
  s_nop 1
  v_permlane32_swap_b32 v48, v50
  v_permlane32_swap_b32 v49, v51
  v_permlane32_swap_b32 v52, v54
  v_permlane32_swap_b32 v53, v55
  buffer_store_dwordx4 v[48:51], v6, s[16:19], 0 offen offset:0
  buffer_store_dwordx4 v[52:55], v6, s[16:19], 0 offen offset:32
  v_and_b32 v3, 31, v1
  v_lshlrev_b32 v3, 12, v3
  v_lshl_add_u32 v3, v4, 4, v3
  s_lshl_b32 s23, s23, 1
  v_cvt_pk_bf16_f32 v56, v32, v33
  v_cvt_pk_bf16_f32 v57, v34, v35
  v_cvt_pk_bf16_f32 v58, v36, v37
  v_cvt_pk_bf16_f32 v59, v38, v39
  v_cvt_pk_bf16_f32 v60, v40, v41
  v_cvt_pk_bf16_f32 v61, v42, v43
  v_cvt_pk_bf16_f32 v62, v44, v45
  v_cvt_pk_bf16_f32 v63, v46, v47
  buffer_store_dwordx4 v[56:59], v3, s[64:67], s23 offen offset:0
  buffer_store_dwordx4 v[60:63], v3, s[64:67], s23 offen offset:32
L_k1_end:
  s_endpgm
.globl k2_attn_kernel
.p2align 8
.type k2_attn_kernel,@function
k2_attn_kernel:
  s_load_dwordx16 s[32:47], s[0:1], 0
  s_load_dwordx8 s[48:55], s[0:1], 64
  s_load_dwordx4 s[56:59], s[0:1], 96
  s_cmp_ge_u32 s2, 256
  s_cbranch_scc1 L_k2_end
  v_and_b32 v1, 63, v0
  v_lshrrev_b32 v19, 6, v0
  s_nop 0
  v_readfirstlane_b32 s20, v19
  s_waitcnt lgkmcnt(0)
  s_nop 3
  s_cmp_ge_u32 s20, 4
  s_cbranch_scc1 L_a_start
L_b_start:
  s_and_b32 s61, s2, 7
  s_lshr_b32 s62, s2, 3
  s_lshl_b32 s61, s61, 2
  s_and_b32 s23, s62, 3
  s_add_u32 s61, s61, s23
  s_lshr_b32 s23, s62, 2
  s_lshl_b32 s64, s61, 8
  s_add_u32 s4, s58, 0x800000
  s_addc_u32 s5, s59, 0
  s_add_u32 s4, s4, s64
  s_addc_u32 s5, s5, 0
  s_sub_u32 s6, 0x1000000, s64
  s_mov_b32 s7, 0x00020000
  s_add_u32 s8, s58, 0x1800000
  s_addc_u32 s9, s59, 0
  s_add_u32 s8, s8, s64
  s_addc_u32 s9, s9, 0
  s_sub_u32 s10, 0x1000000, s64
  s_mov_b32 s11, 0x00020000
  s_add_u32 s12, s58, 0x2800000
  s_addc_u32 s13, s59, 0
  s_add_u32 s12, s12, s64
  s_addc_u32 s13, s13, 0
  s_sub_u32 s14, 0x1000000, s64
  s_mov_b32 s15, 0x00020000
  s_add_u32 s16, s58, 0x3c00000
  s_addc_u32 s17, s59, 0
  s_add_u32 s16, s16, s64
  s_addc_u32 s17, s17, 0
  s_sub_u32 s18, 0x1000000, s64
  s_mov_b32 s19, 0x00020000
  s_mov_b32 s63, 0x5d800000
  s_mov_b32 s66, 0xf149f2ca
  s_lshl_b32 s24, s23, 1
  s_add_u32 s24, s24, 2
  s_mov_b32 s87, 0
  s_lshl_b32 s65, s23, 7
  s_and_b32 s61, s20, 3
  s_lshl_b32 s61, s61, 5
  s_add_u32 s27, s65, s61
  v_and_b32 v19, 31, v1
  v_add_u32 v19, s27, v19
  v_lshrrev_b32 v20, 5, v1
  v_lshlrev_b32 v24, 13, v19
  v_lshl_add_u32 v24, v20, 4, v24
  v_lshlrev_b32 v20, 2, v20
  v_sub_u32 v26, v19, v20
  buffer_load_dwordx4 v[32:35], v24, s[4:7], 0 offen offset:0
  buffer_load_dwordx4 v[36:39], v24, s[4:7], 0 offen offset:32
  buffer_load_dwordx4 v[40:43], v24, s[4:7], 0 offen offset:64
  buffer_load_dwordx4 v[44:47], v24, s[4:7], 0 offen offset:96
  buffer_load_dwordx4 v[48:51], v24, s[4:7], 0 offen offset:128
  buffer_load_dwordx4 v[52:55], v24, s[4:7], 0 offen offset:160
  buffer_load_dwordx4 v[56:59], v24, s[4:7], 0 offen offset:192
  buffer_load_dwordx4 v[60:63], v24, s[4:7], 0 offen offset:224
  v_mov_b32 v136, 0
  v_mov_b32 v137, 0
  v_mov_b32 v138, 0
  v_mov_b32 v139, 0
  v_mov_b32 v140, 0
  v_mov_b32 v141, 0
  v_mov_b32 v142, 0
  v_mov_b32 v143, 0
  v_mov_b32 v144, 0
  v_mov_b32 v145, 0
  v_mov_b32 v146, 0
  v_mov_b32 v147, 0
  v_mov_b32 v148, 0
  v_mov_b32 v149, 0
  v_mov_b32 v150, 0
  v_mov_b32 v151, 0
  v_mov_b32 v17, 0
  s_mov_b32 s98, 1
  v_mov_b32 v192, 0
  v_mov_b32 v193, 0
  v_mov_b32 v194, 0
  v_mov_b32 v195, 0
  v_mov_b32 v196, 0
  v_mov_b32 v197, 0
  v_mov_b32 v198, 0
  v_mov_b32 v199, 0
  v_mov_b32 v200, 0
  v_mov_b32 v201, 0
  v_mov_b32 v202, 0
  v_mov_b32 v203, 0
  v_mov_b32 v204, 0
  v_mov_b32 v205, 0
  v_mov_b32 v206, 0
  v_mov_b32 v207, 0
  v_mov_b32 v208, 0
  v_mov_b32 v209, 0
  v_mov_b32 v210, 0
  v_mov_b32 v211, 0
  v_mov_b32 v212, 0
  v_mov_b32 v213, 0
  v_mov_b32 v214, 0
  v_mov_b32 v215, 0
  v_mov_b32 v216, 0
  v_mov_b32 v217, 0
  v_mov_b32 v218, 0
  v_mov_b32 v219, 0
  v_mov_b32 v220, 0
  v_mov_b32 v221, 0
  v_mov_b32 v222, 0
  v_mov_b32 v223, 0
  v_mov_b32 v224, 0
  v_mov_b32 v225, 0
  v_mov_b32 v226, 0
  v_mov_b32 v227, 0
  v_mov_b32 v228, 0
  v_mov_b32 v229, 0
  v_mov_b32 v230, 0
  v_mov_b32 v231, 0
  v_mov_b32 v232, 0
  v_mov_b32 v233, 0
  v_mov_b32 v234, 0
  v_mov_b32 v235, 0
  v_mov_b32 v236, 0
  v_mov_b32 v237, 0
  v_mov_b32 v238, 0
  v_mov_b32 v239, 0
  v_mov_b32 v240, 0
  v_mov_b32 v241, 0
  v_mov_b32 v242, 0
  v_mov_b32 v243, 0
  v_mov_b32 v244, 0
  v_mov_b32 v245, 0
  v_mov_b32 v246, 0
  v_mov_b32 v247, 0
  v_mov_b32 v248, 0
  v_mov_b32 v249, 0
  v_mov_b32 v250, 0
  v_mov_b32 v251, 0
  v_mov_b32 v252, 0
  v_mov_b32 v253, 0
  v_mov_b32 v254, 0
  v_mov_b32 v255, 0
  s_lshl_b32 s62, s20, 2
  v_lshrrev_b32 v19, 4, v1
  v_add_u32 v20, s62, v19
  v_and_b32 v21, 15, v1
  v_xor_b32 v22, v21, v20
  v_lshlrev_b32 v20, 13, v20
  v_lshl_add_u32 v2, v22, 4, v20
  v_lshlrev_b32 v19, 2, v19
  v_xor_b32 v22, v21, v19
  v_lshl_add_u32 v3, v22, 4, v20
  s_lshl_b32 s31, s20, 10
  s_add_u32 s60, s31, 49152
  s_mov_b32 s21, 0
  s_mov_b32 s22, 0
  v_and_b32 v19, 31, v1
  v_lshlrev_b32 v19, 8, v19
  v_lshrrev_b32 v20, 5, v1
  v_xor_b32 v21, v21, v20
  v_xor_b32 v22, 0, v21
  v_lshl_add_u32 v4, v22, 4, v19
  v_xor_b32 v22, 2, v21
  v_lshl_add_u32 v5, v22, 4, v19
  v_xor_b32 v22, 4, v21
  v_lshl_add_u32 v6, v22, 4, v19
  v_xor_b32 v22, 6, v21
  v_lshl_add_u32 v7, v22, 4, v19
  v_xor_b32 v22, 8, v21
  v_lshl_add_u32 v8, v22, 4, v19
  v_xor_b32 v22, 10, v21
  v_lshl_add_u32 v9, v22, 4, v19
  v_xor_b32 v22, 12, v21
  v_lshl_add_u32 v10, v22, 4, v19
  v_xor_b32 v22, 14, v21
  v_lshl_add_u32 v11, v22, 4, v19
  v_bfe_u32 v19, v1, 2, 2
  v_lshl_add_u32 v20, v20, 2, v19
  v_lshlrev_b32 v20, 8, v20
  v_and_b32 v21, 1, v1
  v_lshl_add_u32 v20, v21, 3, v20
  v_bfe_u32 v21, v1, 4, 1
  v_bfe_u32 v22, v1, 1, 1
  v_lshl_add_u32 v21, v21, 1, v22
  v_lshlrev_b32 v19, 2, v19
  v_add_u32 v22, 0, v21
  v_xor_b32 v22, v22, v19
  v_lshl_add_u32 v12, v22, 4, v20
  v_add_u32 v22, 4, v21
  v_xor_b32 v22, v22, v19
  v_lshl_add_u32 v13, v22, 4, v20
  v_add_u32 v22, 8, v21
  v_xor_b32 v22, v22, v19
  v_lshl_add_u32 v14, v22, 4, v20
  v_add_u32 v22, 12, v21
  v_xor_b32 v22, v22, v19
  v_lshl_add_u32 v15, v22, 4, v20
  s_mov_b32 s68, 0
  s_mov_b32 s69, 0
  s_add_u32 m0, s60, 0
  s_nop 0
  buffer_load_dwordx4 v3, s[12:15], s68 offen lds
  s_add_u32 s68, s68, 131072
  s_add_u32 m0, s60, 4096
  s_nop 0
  buffer_load_dwordx4 v3, s[12:15], s68 offen lds
  s_add_u32 s68, s68, 131072
  s_add_u32 m0, s60, 8192
  s_nop 0
  buffer_load_dwordx4 v3, s[12:15], s68 offen lds
  s_add_u32 s68, s68, 131072
  s_add_u32 m0, s60, 12288
  s_nop 0
  buffer_load_dwordx4 v3, s[12:15], s68 offen lds
  s_add_u32 m0, s31, 0
  s_nop 0
  buffer_load_dwordx4 v2, s[8:11], s69 offen lds
  s_add_u32 s69, s69, 131072
  s_add_u32 m0, s31, 4096
  s_nop 0
  buffer_load_dwordx4 v2, s[8:11], s69 offen lds
  s_add_u32 s69, s69, 131072
  s_add_u32 m0, s31, 8192
  s_nop 0
  buffer_load_dwordx4 v2, s[8:11], s69 offen lds
  s_add_u32 s69, s69, 131072
  s_add_u32 m0, s31, 12288
  s_nop 0
  buffer_load_dwordx4 v2, s[8:11], s69 offen lds
  s_add_u32 s21, s21, 1
  s_cmp_eq_u32 s21, 3
  s_cselect_b32 s21, 0, s21
  s_cselect_b32 s29, -2, 1
  s_lshl_b32 s29, s29, 14
  s_add_u32 s31, s31, s29
  s_add_u32 s60, s60, s29
  s_mov_b32 s68, 524288
  s_mov_b32 s69, 524288
  s_add_u32 m0, s60, 0
  s_nop 0
  buffer_load_dwordx4 v3, s[12:15], s68 offen lds
  s_add_u32 s68, s68, 131072
  s_add_u32 m0, s60, 4096
  s_nop 0
  buffer_load_dwordx4 v3, s[12:15], s68 offen lds
  s_add_u32 s68, s68, 131072
  s_add_u32 m0, s60, 8192
  s_nop 0
  buffer_load_dwordx4 v3, s[12:15], s68 offen lds
  s_add_u32 s68, s68, 131072
  s_add_u32 m0, s60, 12288
  s_nop 0
  buffer_load_dwordx4 v3, s[12:15], s68 offen lds
  s_add_u32 m0, s31, 0
  s_nop 0
  buffer_load_dwordx4 v2, s[8:11], s69 offen lds
  s_add_u32 s69, s69, 131072
  s_add_u32 m0, s31, 4096
  s_nop 0
  buffer_load_dwordx4 v2, s[8:11], s69 offen lds
  s_add_u32 s69, s69, 131072
  s_add_u32 m0, s31, 8192
  s_nop 0
  buffer_load_dwordx4 v2, s[8:11], s69 offen lds
  s_add_u32 s69, s69, 131072
  s_add_u32 m0, s31, 12288
  s_nop 0
  buffer_load_dwordx4 v2, s[8:11], s69 offen lds
  s_add_u32 s21, s21, 1
  s_cmp_eq_u32 s21, 3
  s_cselect_b32 s21, 0, s21
  s_cselect_b32 s29, -2, 1
  s_lshl_b32 s29, s29, 14
  s_add_u32 s31, s31, s29
  s_add_u32 s60, s60, s29
  s_lshl_b32 s61, s23, 8
  s_sub_u32 s61, 1920, s61
  s_lshl_b32 s61, s61, 13
  buffer_load_dwordx4 v[152:155], v24, s[4:7], s61 offen offset:0
  buffer_load_dwordx4 v[156:159], v24, s[4:7], s61 offen offset:32
  buffer_load_dwordx4 v[160:163], v24, s[4:7], s61 offen offset:64
  buffer_load_dwordx4 v[164:167], v24, s[4:7], s61 offen offset:96
  buffer_load_dwordx4 v[168:171], v24, s[4:7], s61 offen offset:128
  buffer_load_dwordx4 v[172:175], v24, s[4:7], s61 offen offset:160
  buffer_load_dwordx4 v[176:179], v24, s[4:7], s61 offen offset:192
  buffer_load_dwordx4 v[180:183], v24, s[4:7], s61 offen offset:224
  s_mov_b32 s25, 0
  s_cmp_ge_u32 s25, s24
  s_cselect_b32 s26, s24, 0
  s_sub_u32 s26, s25, s26
  s_add_u32 s26, s26, s87
  s_lshl_b32 s61, s26, 6
  s_add_u32 s62, s27, 31
  s_cmp_le_u32 s61, s62
  s_cselect_b32 s28, 1, 0
  s_add_u32 s61, s61, 63
  s_cmp_gt_u32 s61, s27
  s_cselect_b32 s30, 1, 0
  s_waitcnt vmcnt(8)
  s_barrier
  ds_read_b128 v[112:115], v4 offset:0
  ds_read_b128 v[116:119], v4 offset:8192
  ds_read_b128 v[120:123], v5 offset:0
  ds_read_b128 v[124:127], v5 offset:8192
  s_waitcnt lgkmcnt(0)
  s_branch L_b_loop1
L_b_loop:
  s_barrier
L_b_loop1:
  s_cmp_eq_u32 s25, s24
  s_cbranch_scc1 L_b_switch
L_b_go:
  s_add_u32 s61, s25, 2
  s_cmp_ge_u32 s61, s24
  s_cselect_b32 s62, s24, 0
  s_sub_u32 s62, s61, s62
  s_add_u32 s62, s62, s87
  s_lshl_b32 s62, s62, 19
  s_cmp_ge_u32 s61, 34
  s_cselect_b32 s68, 0x7f000000, s62
  s_mov_b32 s69, s68
  s_cmp_eq_u32 s28, 0
  s_cbranch_scc1 L_b_inact
  ds_read_b128 v[128:131], v6 offset:0
  v_mfma_f32_32x32x16_bf16 v[64:79], v[112:115], v[32:35], v[136:151]
  ds_read_b128 v[132:135], v6 offset:8192
  v_mfma_f32_32x32x16_bf16 v[80:95], v[116:119], v[32:35], v[136:151]
  s_add_u32 m0, s60, 0
  s_nop 0
  buffer_load_dwordx4 v3, s[12:15], s68 offen lds
  s_add_u32 s68, s68, 131072
  ds_read_b128 v[112:115], v7 offset:0
  v_mfma_f32_32x32x16_bf16 v[64:79], v[120:123], v[36:39], v[64:79]
  ds_read_b128 v[116:119], v7 offset:8192
  v_mfma_f32_32x32x16_bf16 v[80:95], v[124:127], v[36:39], v[80:95]
  s_add_u32 m0, s60, 4096
  s_nop 0
  buffer_load_dwordx4 v3, s[12:15], s68 offen lds
  s_add_u32 s68, s68, 131072
  ds_read_b128 v[120:123], v8 offset:0
  s_waitcnt lgkmcnt(4)
  v_mfma_f32_32x32x16_bf16 v[64:79], v[128:131], v[40:43], v[64:79]
  ds_read_b128 v[124:127], v8 offset:8192
  s_waitcnt lgkmcnt(4)
  v_mfma_f32_32x32x16_bf16 v[80:95], v[132:135], v[40:43], v[80:95]
  s_add_u32 m0, s60, 8192
  s_nop 0
  buffer_load_dwordx4 v3, s[12:15], s68 offen lds
  s_add_u32 s68, s68, 131072
  ds_read_b128 v[128:131], v9 offset:0
  s_waitcnt lgkmcnt(4)
  v_mfma_f32_32x32x16_bf16 v[64:79], v[112:115], v[44:47], v[64:79]
  ds_read_b128 v[132:135], v9 offset:8192
  s_waitcnt lgkmcnt(4)
  v_mfma_f32_32x32x16_bf16 v[80:95], v[116:119], v[44:47], v[80:95]
  s_add_u32 m0, s60, 12288
  s_nop 0
  buffer_load_dwordx4 v3, s[12:15], s68 offen lds
  ds_read_b128 v[112:115], v10 offset:0
  s_waitcnt lgkmcnt(4)
  v_mfma_f32_32x32x16_bf16 v[64:79], v[120:123], v[48:51], v[64:79]
  ds_read_b128 v[116:119], v10 offset:8192
  s_waitcnt lgkmcnt(4)
  v_mfma_f32_32x32x16_bf16 v[80:95], v[124:127], v[48:51], v[80:95]
  s_add_u32 m0, s31, 0
  s_nop 0
  buffer_load_dwordx4 v2, s[8:11], s69 offen lds
  s_add_u32 s69, s69, 131072
  ds_read_b128 v[120:123], v11 offset:0
  s_waitcnt lgkmcnt(4)
  v_mfma_f32_32x32x16_bf16 v[64:79], v[128:131], v[52:55], v[64:79]
  ds_read_b128 v[124:127], v11 offset:8192
  s_waitcnt lgkmcnt(4)
  v_mfma_f32_32x32x16_bf16 v[80:95], v[132:135], v[52:55], v[80:95]
  s_add_u32 m0, s31, 4096
  s_nop 0
  buffer_load_dwordx4 v2, s[8:11], s69 offen lds
  s_add_u32 s69, s69, 131072
  s_waitcnt lgkmcnt(3)
  v_mfma_f32_32x32x16_bf16 v[64:79], v[112:115], v[56:59], v[64:79]
  s_waitcnt lgkmcnt(2)
  v_mfma_f32_32x32x16_bf16 v[80:95], v[116:119], v[56:59], v[80:95]
  s_add_u32 m0, s31, 8192
  s_nop 0
  buffer_load_dwordx4 v2, s[8:11], s69 offen lds
  s_add_u32 s69, s69, 131072
  s_waitcnt lgkmcnt(1)
  v_mfma_f32_32x32x16_bf16 v[64:79], v[120:123], v[60:63], v[64:79]
  s_waitcnt lgkmcnt(0)
  v_mfma_f32_32x32x16_bf16 v[80:95], v[124:127], v[60:63], v[80:95]
  s_add_u32 m0, s31, 12288
  s_nop 0
  buffer_load_dwordx4 v2, s[8:11], s69 offen lds
  s_add_u32 s21, s21, 1
  s_cmp_eq_u32 s21, 3
  s_cselect_b32 s21, 0, s21
  s_cselect_b32 s29, -2, 1
  s_lshl_b32 s29, s29, 14
  s_add_u32 s31, s31, s29
  s_add_u32 s60, s60, s29
  ds_read_b64_tr_b16 v[112:113], v12 offset:49152
  ds_read_b64_tr_b16 v[114:115], v12 offset:51200
  ds_read_b64_tr_b16 v[116:117], v13 offset:49152
  ds_read_b64_tr_b16 v[118:119], v13 offset:51200
  ds_read_b64_tr_b16 v[120:121], v14 offset:49152
  ds_read_b64_tr_b16 v[122:123], v14 offset:51200
  ds_read_b64_tr_b16 v[124:125], v15 offset:49152
  ds_read_b64_tr_b16 v[126:127], v15 offset:51200
  s_nop 3
  s_cmp_eq_u32 s30, 0
  s_cbranch_scc1 L_b_nomask
  s_lshl_b32 s61, s26, 6
  v_subrev_u32 v25, s61, v26
  v_mov_b32 v19, s66
  v_cmp_le_i32 s[88:89], 0, v25
  v_cmp_le_i32 s[90:91], 1, v25
  v_cmp_le_i32 s[92:93], 2, v25
  v_cmp_le_i32 s[94:95], 3, v25
  v_cndmask_b32 v64, v19, v64, s[88:89]
  v_cndmask_b32 v65, v19, v65, s[90:91]
  v_cndmask_b32 v66, v19, v66, s[92:93]
  v_cndmask_b32 v67, v19, v67, s[94:95]
  v_cmp_le_i32 s[88:89], 8, v25
  v_cmp_le_i32 s[90:91], 9, v25
  v_cmp_le_i32 s[92:93], 10, v25
  v_cmp_le_i32 s[94:95], 11, v25
  v_cndmask_b32 v68, v19, v68, s[88:89]
  v_cndmask_b32 v69, v19, v69, s[90:91]
  v_cndmask_b32 v70, v19, v70, s[92:93]
  v_cndmask_b32 v71, v19, v71, s[94:95]
  v_cmp_le_i32 s[88:89], 16, v25
  v_cmp_le_i32 s[90:91], 17, v25
  v_cmp_le_i32 s[92:93], 18, v25
  v_cmp_le_i32 s[94:95], 19, v25
  v_cndmask_b32 v72, v19, v72, s[88:89]
  v_cndmask_b32 v73, v19, v73, s[90:91]
  v_cndmask_b32 v74, v19, v74, s[92:93]
  v_cndmask_b32 v75, v19, v75, s[94:95]
  v_cmp_le_i32 s[88:89], 24, v25
  v_cmp_le_i32 s[90:91], 25, v25
  v_cmp_le_i32 s[92:93], 26, v25
  v_cmp_le_i32 s[94:95], 27, v25
  v_cndmask_b32 v76, v19, v76, s[88:89]
  v_cndmask_b32 v77, v19, v77, s[90:91]
  v_cndmask_b32 v78, v19, v78, s[92:93]
  v_cndmask_b32 v79, v19, v79, s[94:95]
  v_cmp_le_i32 s[88:89], 32, v25
  v_cmp_le_i32 s[90:91], 33, v25
  v_cmp_le_i32 s[92:93], 34, v25
  v_cmp_le_i32 s[94:95], 35, v25
  v_cndmask_b32 v80, v19, v80, s[88:89]
  v_cndmask_b32 v81, v19, v81, s[90:91]
  v_cndmask_b32 v82, v19, v82, s[92:93]
  v_cndmask_b32 v83, v19, v83, s[94:95]
  v_cmp_le_i32 s[88:89], 40, v25
  v_cmp_le_i32 s[90:91], 41, v25
  v_cmp_le_i32 s[92:93], 42, v25
  v_cmp_le_i32 s[94:95], 43, v25
  v_cndmask_b32 v84, v19, v84, s[88:89]
  v_cndmask_b32 v85, v19, v85, s[90:91]
  v_cndmask_b32 v86, v19, v86, s[92:93]
  v_cndmask_b32 v87, v19, v87, s[94:95]
  v_cmp_le_i32 s[88:89], 48, v25
  v_cmp_le_i32 s[90:91], 49, v25
  v_cmp_le_i32 s[92:93], 50, v25
  v_cmp_le_i32 s[94:95], 51, v25
  v_cndmask_b32 v88, v19, v88, s[88:89]
  v_cndmask_b32 v89, v19, v89, s[90:91]
  v_cndmask_b32 v90, v19, v90, s[92:93]
  v_cndmask_b32 v91, v19, v91, s[94:95]
  v_cmp_le_i32 s[88:89], 56, v25
  v_cmp_le_i32 s[90:91], 57, v25
  v_cmp_le_i32 s[92:93], 58, v25
  v_cmp_le_i32 s[94:95], 59, v25
  v_cndmask_b32 v92, v19, v92, s[88:89]
  v_cndmask_b32 v93, v19, v93, s[90:91]
  v_cndmask_b32 v94, v19, v94, s[92:93]
  v_cndmask_b32 v95, v19, v95, s[94:95]
L_b_nomask:
  s_cmp_eq_u32 s98, 1
  s_cbranch_scc1 L_b_first
  v_exp_f32 v184, v64
  v_exp_f32 v185, v65
  v_exp_f32 v186, v66
  v_exp_f32 v187, v67
  v_cvt_pk_bf16_f32 v96, v184, v185
  v_mov_b32 v18, v184
  v_mov_b32 v27, v185
  v_exp_f32 v188, v68
  v_exp_f32 v189, v69
  v_cvt_pk_bf16_f32 v97, v186, v187
  v_add_f32 v18, v18, v186
  v_add_f32 v27, v27, v187
  v_exp_f32 v190, v70
  v_exp_f32 v191, v71
  v_cvt_pk_bf16_f32 v98, v188, v189
  v_add_f32 v18, v18, v188
  v_add_f32 v27, v27, v189
  v_exp_f32 v184, v72
  v_exp_f32 v185, v73
  v_cvt_pk_bf16_f32 v99, v190, v191
  v_add_f32 v18, v18, v190
  v_add_f32 v27, v27, v191
  v_exp_f32 v186, v74
  v_exp_f32 v187, v75
  v_cvt_pk_bf16_f32 v100, v184, v185
  v_add_f32 v18, v18, v184
  v_add_f32 v27, v27, v185
  v_exp_f32 v188, v76
  v_exp_f32 v189, v77
  v_cvt_pk_bf16_f32 v101, v186, v187
  v_add_f32 v18, v18, v186
  v_add_f32 v27, v27, v187
  v_exp_f32 v190, v78
  v_exp_f32 v191, v79
  v_cvt_pk_bf16_f32 v102, v188, v189
  v_add_f32 v18, v18, v188
  v_add_f32 v27, v27, v189
  v_exp_f32 v184, v80
  v_exp_f32 v185, v81
  v_cvt_pk_bf16_f32 v103, v190, v191
  v_add_f32 v18, v18, v190
  v_add_f32 v27, v27, v191
  v_exp_f32 v186, v82
  v_exp_f32 v187, v83
  v_cvt_pk_bf16_f32 v104, v184, v185
  v_add_f32 v18, v18, v184
  v_add_f32 v27, v27, v185
  v_exp_f32 v188, v84
  v_exp_f32 v189, v85
  v_cvt_pk_bf16_f32 v105, v186, v187
  v_add_f32 v18, v18, v186
  v_add_f32 v27, v27, v187
  v_exp_f32 v190, v86
  v_exp_f32 v191, v87
  v_cvt_pk_bf16_f32 v106, v188, v189
  v_add_f32 v18, v18, v188
  v_add_f32 v27, v27, v189
  v_exp_f32 v184, v88
  v_exp_f32 v185, v89
  v_cvt_pk_bf16_f32 v107, v190, v191
  v_add_f32 v18, v18, v190
  v_add_f32 v27, v27, v191
  v_exp_f32 v186, v90
  v_exp_f32 v187, v91
  v_cvt_pk_bf16_f32 v108, v184, v185
  v_add_f32 v18, v18, v184
  v_add_f32 v27, v27, v185
  v_exp_f32 v188, v92
  v_exp_f32 v189, v93
  v_cvt_pk_bf16_f32 v109, v186, v187
  v_add_f32 v18, v18, v186
  v_add_f32 v27, v27, v187
  v_exp_f32 v190, v94
  v_exp_f32 v191, v95
  v_cvt_pk_bf16_f32 v110, v188, v189
  v_add_f32 v18, v18, v188
  v_add_f32 v27, v27, v189
  s_nop 0
  v_cvt_pk_bf16_f32 v111, v190, v191
  v_add_f32 v18, v18, v190
  v_add_f32 v27, v27, v191
  s_nop 0
  v_add_f32 v18, v18, v27
  v_cmp_nge_f32 vcc, s63, v18
  s_nop 0
  s_cbranch_vccnz L_b_fallback
L_b_cont:
  v_add_f32 v17, v17, v18
  s_waitcnt lgkmcnt(0)
  ds_read_b64_tr_b16 v[128:129], v12 offset:53248
  ds_read_b64_tr_b16 v[130:131], v12 offset:55296
  v_mfma_f32_32x32x16_bf16 v[192:207], v[112:115], v[96:99], v[192:207]
  ds_read_b64_tr_b16 v[132:133], v13 offset:53248
  ds_read_b64_tr_b16 v[134:135], v13 offset:55296
  v_mfma_f32_32x32x16_bf16 v[208:223], v[116:119], v[96:99], v[208:223]
  ds_read_b64_tr_b16 v[112:113], v14 offset:53248
  ds_read_b64_tr_b16 v[114:115], v14 offset:55296
  v_mfma_f32_32x32x16_bf16 v[224:239], v[120:123], v[96:99], v[224:239]
  ds_read_b64_tr_b16 v[116:117], v15 offset:53248
  ds_read_b64_tr_b16 v[118:119], v15 offset:55296
  v_mfma_f32_32x32x16_bf16 v[240:255], v[124:127], v[96:99], v[240:255]
  ds_read_b64_tr_b16 v[120:121], v12 offset:57344
  ds_read_b64_tr_b16 v[122:123], v12 offset:59392
  s_waitcnt lgkmcnt(8)
  v_mfma_f32_32x32x16_bf16 v[192:207], v[128:131], v[100:103], v[192:207]
  ds_read_b64_tr_b16 v[124:125], v13 offset:57344
  ds_read_b64_tr_b16 v[126:127], v13 offset:59392
  s_waitcnt lgkmcnt(8)
  v_mfma_f32_32x32x16_bf16 v[208:223], v[132:135], v[100:103], v[208:223]
  ds_read_b64_tr_b16 v[128:129], v14 offset:57344
  ds_read_b64_tr_b16 v[130:131], v14 offset:59392
  s_waitcnt lgkmcnt(8)
  v_mfma_f32_32x32x16_bf16 v[224:239], v[112:115], v[100:103], v[224:239]
  ds_read_b64_tr_b16 v[132:133], v15 offset:57344
  ds_read_b64_tr_b16 v[134:135], v15 offset:59392
  s_waitcnt lgkmcnt(8)
  v_mfma_f32_32x32x16_bf16 v[240:255], v[116:119], v[100:103], v[240:255]
  ds_read_b64_tr_b16 v[112:113], v12 offset:61440
  ds_read_b64_tr_b16 v[114:115], v12 offset:63488
  s_waitcnt lgkmcnt(8)
  v_mfma_f32_32x32x16_bf16 v[192:207], v[120:123], v[104:107], v[192:207]
  ds_read_b64_tr_b16 v[116:117], v13 offset:61440
  ds_read_b64_tr_b16 v[118:119], v13 offset:63488
  s_waitcnt lgkmcnt(8)
  v_mfma_f32_32x32x16_bf16 v[208:223], v[124:127], v[104:107], v[208:223]
  ds_read_b64_tr_b16 v[120:121], v14 offset:61440
  ds_read_b64_tr_b16 v[122:123], v14 offset:63488
  s_waitcnt lgkmcnt(8)
  v_mfma_f32_32x32x16_bf16 v[224:239], v[128:131], v[104:107], v[224:239]
  ds_read_b64_tr_b16 v[124:125], v15 offset:61440
  ds_read_b64_tr_b16 v[126:127], v15 offset:63488
  s_waitcnt lgkmcnt(8)
  v_mfma_f32_32x32x16_bf16 v[240:255], v[132:135], v[104:107], v[240:255]
  s_waitcnt lgkmcnt(6)
  v_mfma_f32_32x32x16_bf16 v[192:207], v[112:115], v[108:111], v[192:207]
  s_waitcnt lgkmcnt(4)
  v_mfma_f32_32x32x16_bf16 v[208:223], v[116:119], v[108:111], v[208:223]
  s_waitcnt lgkmcnt(2)
  v_mfma_f32_32x32x16_bf16 v[224:239], v[120:123], v[108:111], v[224:239]
  s_waitcnt lgkmcnt(0)
  v_mfma_f32_32x32x16_bf16 v[240:255], v[124:127], v[108:111], v[240:255]
L_b_end:
  s_add_u32 s22, s22, 1
  s_cmp_eq_u32 s22, 3
  s_cselect_b32 s22, 0, s22
  s_cselect_b32 s29, -2, 1
  s_lshl_b32 s29, s29, 14
  v_add_u32 v4, s29, v4
  v_add_u32 v5, s29, v5
  v_add_u32 v6, s29, v6
  v_add_u32 v7, s29, v7
  v_add_u32 v8, s29, v8
  v_add_u32 v9, s29, v9
  v_add_u32 v10, s29, v10
  v_add_u32 v11, s29, v11
  v_add_u32 v12, s29, v12
  v_add_u32 v13, s29, v13
  v_add_u32 v14, s29, v14
  v_add_u32 v15, s29, v15
  ds_read_b128 v[112:115], v4 offset:0
  ds_read_b128 v[116:119], v4 offset:8192
  ds_read_b128 v[120:123], v5 offset:0
  ds_read_b128 v[124:127], v5 offset:8192
  s_add_u32 s25, s25, 1
  s_cmp_ge_u32 s25, s24
  s_cselect_b32 s26, s24, 0
  s_sub_u32 s26, s25, s26
  s_add_u32 s26, s26, s87
  s_lshl_b32 s61, s26, 6
  s_add_u32 s62, s27, 31
  s_cmp_le_u32 s61, s62
  s_cselect_b32 s28, 1, 0
  s_add_u32 s61, s61, 63
  s_cmp_gt_u32 s61, s27
  s_cselect_b32 s30, 1, 0
  s_waitcnt vmcnt(0) lgkmcnt(0)
  s_cmp_lt_u32 s25, 34
  s_cbranch_scc1 L_b_loop
  s_nop 15
  v_mov_b32 v19, v17
  v_mov_b32 v20, v17
  s_nop 1
  v_permlane32_swap_b32 v19, v20
  v_add_f32 v19, v19, v20
  v_rcp_f32 v19, v19
  s_nop 0
  v_mul_f32 v192, v19, v192
  v_mul_f32 v193, v19, v193
  v_mul_f32 v194, v19, v194
  v_mul_f32 v195, v19, v195
  v_mul_f32 v196, v19, v196
  v_mul_f32 v197, v19, v197
  v_mul_f32 v198, v19, v198
  v_mul_f32 v199, v19, v199
  v_mul_f32 v200, v19, v200
  v_mul_f32 v201, v19, v201
  v_mul_f32 v202, v19, v202
  v_mul_f32 v203, v19, v203
  v_mul_f32 v204, v19, v204
  v_mul_f32 v205, v19, v205
  v_mul_f32 v206, v19, v206
  v_mul_f32 v207, v19, v207
  v_cvt_pk_bf16_f32 v112, v192, v193
  v_cvt_pk_bf16_f32 v113, v194, v195
  v_cvt_pk_bf16_f32 v114, v196, v197
  v_cvt_pk_bf16_f32 v115, v198, v199
  v_cvt_pk_bf16_f32 v116, v200, v201
  v_cvt_pk_bf16_f32 v117, v202, v203
  v_cvt_pk_bf16_f32 v118, v204, v205
  v_cvt_pk_bf16_f32 v119, v206, v207
  s_nop 1
  v_permlane32_swap_b32 v112, v114
  v_permlane32_swap_b32 v113, v115
  v_permlane32_swap_b32 v116, v118
  v_permlane32_swap_b32 v117, v119
  buffer_store_dwordx4 v[112:115], v24, s[16:19], 0 offen offset:0
  buffer_store_dwordx4 v[116:119], v24, s[16:19], 0 offen offset:32
  v_mul_f32 v208, v19, v208
  v_mul_f32 v209, v19, v209
  v_mul_f32 v210, v19, v210
  v_mul_f32 v211, v19, v211
  v_mul_f32 v212, v19, v212
  v_mul_f32 v213, v19, v213
  v_mul_f32 v214, v19, v214
  v_mul_f32 v215, v19, v215
  v_mul_f32 v216, v19, v216
  v_mul_f32 v217, v19, v217
  v_mul_f32 v218, v19, v218
  v_mul_f32 v219, v19, v219
  v_mul_f32 v220, v19, v220
  v_mul_f32 v221, v19, v221
  v_mul_f32 v222, v19, v222
  v_mul_f32 v223, v19, v223
  v_cvt_pk_bf16_f32 v120, v208, v209
  v_cvt_pk_bf16_f32 v121, v210, v211
  v_cvt_pk_bf16_f32 v122, v212, v213
  v_cvt_pk_bf16_f32 v123, v214, v215
  v_cvt_pk_bf16_f32 v124, v216, v217
  v_cvt_pk_bf16_f32 v125, v218, v219
  v_cvt_pk_bf16_f32 v126, v220, v221
  v_cvt_pk_bf16_f32 v127, v222, v223
  s_nop 1
  v_permlane32_swap_b32 v120, v122
  v_permlane32_swap_b32 v121, v123
  v_permlane32_swap_b32 v124, v126
  v_permlane32_swap_b32 v125, v127
  buffer_store_dwordx4 v[120:123], v24, s[16:19], 0 offen offset:64
  buffer_store_dwordx4 v[124:127], v24, s[16:19], 0 offen offset:96
  v_mul_f32 v224, v19, v224
  v_mul_f32 v225, v19, v225
  v_mul_f32 v226, v19, v226
  v_mul_f32 v227, v19, v227
  v_mul_f32 v228, v19, v228
  v_mul_f32 v229, v19, v229
  v_mul_f32 v230, v19, v230
  v_mul_f32 v231, v19, v231
  v_mul_f32 v232, v19, v232
  v_mul_f32 v233, v19, v233
  v_mul_f32 v234, v19, v234
  v_mul_f32 v235, v19, v235
  v_mul_f32 v236, v19, v236
  v_mul_f32 v237, v19, v237
  v_mul_f32 v238, v19, v238
  v_mul_f32 v239, v19, v239
  v_cvt_pk_bf16_f32 v128, v224, v225
  v_cvt_pk_bf16_f32 v129, v226, v227
  v_cvt_pk_bf16_f32 v130, v228, v229
  v_cvt_pk_bf16_f32 v131, v230, v231
  v_cvt_pk_bf16_f32 v132, v232, v233
  v_cvt_pk_bf16_f32 v133, v234, v235
  v_cvt_pk_bf16_f32 v134, v236, v237
  v_cvt_pk_bf16_f32 v135, v238, v239
  s_nop 1
  v_permlane32_swap_b32 v128, v130
  v_permlane32_swap_b32 v129, v131
  v_permlane32_swap_b32 v132, v134
  v_permlane32_swap_b32 v133, v135
  buffer_store_dwordx4 v[128:131], v24, s[16:19], 0 offen offset:128
  buffer_store_dwordx4 v[132:135], v24, s[16:19], 0 offen offset:160
  v_mul_f32 v240, v19, v240
  v_mul_f32 v241, v19, v241
  v_mul_f32 v242, v19, v242
  v_mul_f32 v243, v19, v243
  v_mul_f32 v244, v19, v244
  v_mul_f32 v245, v19, v245
  v_mul_f32 v246, v19, v246
  v_mul_f32 v247, v19, v247
  v_mul_f32 v248, v19, v248
  v_mul_f32 v249, v19, v249
  v_mul_f32 v250, v19, v250
  v_mul_f32 v251, v19, v251
  v_mul_f32 v252, v19, v252
  v_mul_f32 v253, v19, v253
  v_mul_f32 v254, v19, v254
  v_mul_f32 v255, v19, v255
  v_cvt_pk_bf16_f32 v136, v240, v241
  v_cvt_pk_bf16_f32 v137, v242, v243
  v_cvt_pk_bf16_f32 v138, v244, v245
  v_cvt_pk_bf16_f32 v139, v246, v247
  v_cvt_pk_bf16_f32 v140, v248, v249
  v_cvt_pk_bf16_f32 v141, v250, v251
  v_cvt_pk_bf16_f32 v142, v252, v253
  v_cvt_pk_bf16_f32 v143, v254, v255
  s_nop 1
  v_permlane32_swap_b32 v136, v138
  v_permlane32_swap_b32 v137, v139
  v_permlane32_swap_b32 v140, v142
  v_permlane32_swap_b32 v141, v143
  buffer_store_dwordx4 v[136:139], v24, s[16:19], 0 offen offset:192
  buffer_store_dwordx4 v[140:143], v24, s[16:19], 0 offen offset:224
  s_branch L_k2_end
L_b_inact:
  s_add_u32 m0, s60, 0
  s_nop 0
  buffer_load_dwordx4 v3, s[12:15], s68 offen lds
  s_add_u32 s68, s68, 131072
  s_add_u32 m0, s60, 4096
  s_nop 0
  buffer_load_dwordx4 v3, s[12:15], s68 offen lds
  s_add_u32 s68, s68, 131072
  s_add_u32 m0, s60, 8192
  s_nop 0
  buffer_load_dwordx4 v3, s[12:15], s68 offen lds
  s_add_u32 s68, s68, 131072
  s_add_u32 m0, s60, 12288
  s_nop 0
  buffer_load_dwordx4 v3, s[12:15], s68 offen lds
  s_add_u32 m0, s31, 0
  s_nop 0
  buffer_load_dwordx4 v2, s[8:11], s69 offen lds
  s_add_u32 s69, s69, 131072
  s_add_u32 m0, s31, 4096
  s_nop 0
  buffer_load_dwordx4 v2, s[8:11], s69 offen lds
  s_add_u32 s69, s69, 131072
  s_add_u32 m0, s31, 8192
  s_nop 0
  buffer_load_dwordx4 v2, s[8:11], s69 offen lds
  s_add_u32 s69, s69, 131072
  s_add_u32 m0, s31, 12288
  s_nop 0
  buffer_load_dwordx4 v2, s[8:11], s69 offen lds
  s_add_u32 s21, s21, 1
  s_cmp_eq_u32 s21, 3
  s_cselect_b32 s21, 0, s21
  s_cselect_b32 s29, -2, 1
  s_lshl_b32 s29, s29, 14
  s_add_u32 s31, s31, s29
  s_add_u32 s60, s60, s29
  s_branch L_b_end
L_b_switch:
  s_nop 15
  v_mov_b32 v19, v17
  v_mov_b32 v20, v17
  s_nop 1
  v_permlane32_swap_b32 v19, v20
  v_add_f32 v19, v19, v20
  v_rcp_f32 v19, v19
  s_nop 0
  v_mul_f32 v192, v19, v192
  v_mul_f32 v193, v19, v193
  v_mul_f32 v194, v19, v194
  v_mul_f32 v195, v19, v195
  v_mul_f32 v196, v19, v196
  v_mul_f32 v197, v19, v197
  v_mul_f32 v198, v19, v198
  v_mul_f32 v199, v19, v199
  v_mul_f32 v200, v19, v200
  v_mul_f32 v201, v19, v201
  v_mul_f32 v202, v19, v202
  v_mul_f32 v203, v19, v203
  v_mul_f32 v204, v19, v204
  v_mul_f32 v205, v19, v205
  v_mul_f32 v206, v19, v206
  v_mul_f32 v207, v19, v207
  v_cvt_pk_bf16_f32 v112, v192, v193
  v_cvt_pk_bf16_f32 v113, v194, v195
  v_cvt_pk_bf16_f32 v114, v196, v197
  v_cvt_pk_bf16_f32 v115, v198, v199
  v_cvt_pk_bf16_f32 v116, v200, v201
  v_cvt_pk_bf16_f32 v117, v202, v203
  v_cvt_pk_bf16_f32 v118, v204, v205
  v_cvt_pk_bf16_f32 v119, v206, v207
  s_nop 1
  v_permlane32_swap_b32 v112, v114
  v_permlane32_swap_b32 v113, v115
  v_permlane32_swap_b32 v116, v118
  v_permlane32_swap_b32 v117, v119
  buffer_store_dwordx4 v[112:115], v24, s[16:19], 0 offen offset:0
  buffer_store_dwordx4 v[116:119], v24, s[16:19], 0 offen offset:32
  v_mul_f32 v208, v19, v208
  v_mul_f32 v209, v19, v209
  v_mul_f32 v210, v19, v210
  v_mul_f32 v211, v19, v211
  v_mul_f32 v212, v19, v212
  v_mul_f32 v213, v19, v213
  v_mul_f32 v214, v19, v214
  v_mul_f32 v215, v19, v215
  v_mul_f32 v216, v19, v216
  v_mul_f32 v217, v19, v217
  v_mul_f32 v218, v19, v218
  v_mul_f32 v219, v19, v219
  v_mul_f32 v220, v19, v220
  v_mul_f32 v221, v19, v221
  v_mul_f32 v222, v19, v222
  v_mul_f32 v223, v19, v223
  v_cvt_pk_bf16_f32 v120, v208, v209
  v_cvt_pk_bf16_f32 v121, v210, v211
  v_cvt_pk_bf16_f32 v122, v212, v213
  v_cvt_pk_bf16_f32 v123, v214, v215
  v_cvt_pk_bf16_f32 v124, v216, v217
  v_cvt_pk_bf16_f32 v125, v218, v219
  v_cvt_pk_bf16_f32 v126, v220, v221
  v_cvt_pk_bf16_f32 v127, v222, v223
  s_nop 1
  v_permlane32_swap_b32 v120, v122
  v_permlane32_swap_b32 v121, v123
  v_permlane32_swap_b32 v124, v126
  v_permlane32_swap_b32 v125, v127
  buffer_store_dwordx4 v[120:123], v24, s[16:19], 0 offen offset:64
  buffer_store_dwordx4 v[124:127], v24, s[16:19], 0 offen offset:96
  v_mul_f32 v224, v19, v224
  v_mul_f32 v225, v19, v225
  v_mul_f32 v226, v19, v226
  v_mul_f32 v227, v19, v227
  v_mul_f32 v228, v19, v228
  v_mul_f32 v229, v19, v229
  v_mul_f32 v230, v19, v230
  v_mul_f32 v231, v19, v231
  v_mul_f32 v232, v19, v232
  v_mul_f32 v233, v19, v233
  v_mul_f32 v234, v19, v234
  v_mul_f32 v235, v19, v235
  v_mul_f32 v236, v19, v236
  v_mul_f32 v237, v19, v237
  v_mul_f32 v238, v19, v238
  v_mul_f32 v239, v19, v239
  v_cvt_pk_bf16_f32 v128, v224, v225
  v_cvt_pk_bf16_f32 v129, v226, v227
  v_cvt_pk_bf16_f32 v130, v228, v229
  v_cvt_pk_bf16_f32 v131, v230, v231
  v_cvt_pk_bf16_f32 v132, v232, v233
  v_cvt_pk_bf16_f32 v133, v234, v235
  v_cvt_pk_bf16_f32 v134, v236, v237
  v_cvt_pk_bf16_f32 v135, v238, v239
  s_nop 1
  v_permlane32_swap_b32 v128, v130
  v_permlane32_swap_b32 v129, v131
  v_permlane32_swap_b32 v132, v134
  v_permlane32_swap_b32 v133, v135
  buffer_store_dwordx4 v[128:131], v24, s[16:19], 0 offen offset:128
  buffer_store_dwordx4 v[132:135], v24, s[16:19], 0 offen offset:160
  v_mul_f32 v240, v19, v240
  v_mul_f32 v241, v19, v241
  v_mul_f32 v242, v19, v242
  v_mul_f32 v243, v19, v243
  v_mul_f32 v244, v19, v244
  v_mul_f32 v245, v19, v245
  v_mul_f32 v246, v19, v246
  v_mul_f32 v247, v19, v247
  v_mul_f32 v248, v19, v248
  v_mul_f32 v249, v19, v249
  v_mul_f32 v250, v19, v250
  v_mul_f32 v251, v19, v251
  v_mul_f32 v252, v19, v252
  v_mul_f32 v253, v19, v253
  v_mul_f32 v254, v19, v254
  v_mul_f32 v255, v19, v255
  v_cvt_pk_bf16_f32 v136, v240, v241
  v_cvt_pk_bf16_f32 v137, v242, v243
  v_cvt_pk_bf16_f32 v138, v244, v245
  v_cvt_pk_bf16_f32 v139, v246, v247
  v_cvt_pk_bf16_f32 v140, v248, v249
  v_cvt_pk_bf16_f32 v141, v250, v251
  v_cvt_pk_bf16_f32 v142, v252, v253
  v_cvt_pk_bf16_f32 v143, v254, v255
  s_nop 1
  v_permlane32_swap_b32 v136, v138
  v_permlane32_swap_b32 v137, v139
  v_permlane32_swap_b32 v140, v142
  v_permlane32_swap_b32 v141, v143
  buffer_store_dwordx4 v[136:139], v24, s[16:19], 0 offen offset:192
  buffer_store_dwordx4 v[140:143], v24, s[16:19], 0 offen offset:224
  s_lshl_b32 s61, s23, 7
  s_sub_u32 s65, 1920, s61
  s_nop 1
  s_and_b32 s61, s20, 3
  s_lshl_b32 s61, s61, 5
  s_add_u32 s27, s65, s61
  v_and_b32 v19, 31, v1
  v_add_u32 v19, s27, v19
  v_lshrrev_b32 v20, 5, v1
  v_lshlrev_b32 v24, 13, v19
  v_lshl_add_u32 v24, v20, 4, v24
  v_lshlrev_b32 v20, 2, v20
  v_sub_u32 v26, v19, v20
  v_mov_b32 v32, v152
  v_mov_b32 v33, v153
  v_mov_b32 v34, v154
  v_mov_b32 v35, v155
  v_mov_b32 v36, v156
  v_mov_b32 v37, v157
  v_mov_b32 v38, v158
  v_mov_b32 v39, v159
  v_mov_b32 v40, v160
  v_mov_b32 v41, v161
  v_mov_b32 v42, v162
  v_mov_b32 v43, v163
  v_mov_b32 v44, v164
  v_mov_b32 v45, v165
  v_mov_b32 v46, v166
  v_mov_b32 v47, v167
  v_mov_b32 v48, v168
  v_mov_b32 v49, v169
  v_mov_b32 v50, v170
  v_mov_b32 v51, v171
  v_mov_b32 v52, v172
  v_mov_b32 v53, v173
  v_mov_b32 v54, v174
  v_mov_b32 v55, v175
  v_mov_b32 v56, v176
  v_mov_b32 v57, v177
  v_mov_b32 v58, v178
  v_mov_b32 v59, v179
  v_mov_b32 v60, v180
  v_mov_b32 v61, v181
  v_mov_b32 v62, v182
  v_mov_b32 v63, v183
  v_mov_b32 v136, 0
  v_mov_b32 v137, 0
  v_mov_b32 v138, 0
  v_mov_b32 v139, 0
  v_mov_b32 v140, 0
  v_mov_b32 v141, 0
  v_mov_b32 v142, 0
  v_mov_b32 v143, 0
  v_mov_b32 v144, 0
  v_mov_b32 v145, 0
  v_mov_b32 v146, 0
  v_mov_b32 v147, 0
  v_mov_b32 v148, 0
  v_mov_b32 v149, 0
  v_mov_b32 v150, 0
  v_mov_b32 v151, 0
  v_mov_b32 v17, 0
  s_mov_b32 s98, 1
  v_mov_b32 v192, 0
  v_mov_b32 v193, 0
  v_mov_b32 v194, 0
  v_mov_b32 v195, 0
  v_mov_b32 v196, 0
  v_mov_b32 v197, 0
  v_mov_b32 v198, 0
  v_mov_b32 v199, 0
  v_mov_b32 v200, 0
  v_mov_b32 v201, 0
  v_mov_b32 v202, 0
  v_mov_b32 v203, 0
  v_mov_b32 v204, 0
  v_mov_b32 v205, 0
  v_mov_b32 v206, 0
  v_mov_b32 v207, 0
  v_mov_b32 v208, 0
  v_mov_b32 v209, 0
  v_mov_b32 v210, 0
  v_mov_b32 v211, 0
  v_mov_b32 v212, 0
  v_mov_b32 v213, 0
  v_mov_b32 v214, 0
  v_mov_b32 v215, 0
  v_mov_b32 v216, 0
  v_mov_b32 v217, 0
  v_mov_b32 v218, 0
  v_mov_b32 v219, 0
  v_mov_b32 v220, 0
  v_mov_b32 v221, 0
  v_mov_b32 v222, 0
  v_mov_b32 v223, 0
  v_mov_b32 v224, 0
  v_mov_b32 v225, 0
  v_mov_b32 v226, 0
  v_mov_b32 v227, 0
  v_mov_b32 v228, 0
  v_mov_b32 v229, 0
  v_mov_b32 v230, 0
  v_mov_b32 v231, 0
  v_mov_b32 v232, 0
  v_mov_b32 v233, 0
  v_mov_b32 v234, 0
  v_mov_b32 v235, 0
  v_mov_b32 v236, 0
  v_mov_b32 v237, 0
  v_mov_b32 v238, 0
  v_mov_b32 v239, 0
  v_mov_b32 v240, 0
  v_mov_b32 v241, 0
  v_mov_b32 v242, 0
  v_mov_b32 v243, 0
  v_mov_b32 v244, 0
  v_mov_b32 v245, 0
  v_mov_b32 v246, 0
  v_mov_b32 v247, 0
  v_mov_b32 v248, 0
  v_mov_b32 v249, 0
  v_mov_b32 v250, 0
  v_mov_b32 v251, 0
  v_mov_b32 v252, 0
  v_mov_b32 v253, 0
  v_mov_b32 v254, 0
  v_mov_b32 v255, 0
  s_cmp_ge_u32 s25, s24
  s_cselect_b32 s26, s24, 0
  s_sub_u32 s26, s25, s26
  s_add_u32 s26, s26, s87
  s_lshl_b32 s61, s26, 6
  s_add_u32 s62, s27, 31
  s_cmp_le_u32 s61, s62
  s_cselect_b32 s28, 1, 0
  s_add_u32 s61, s61, 63
  s_cmp_gt_u32 s61, s27
  s_cselect_b32 s30, 1, 0
  ds_read_b128 v[112:115], v4 offset:0
  ds_read_b128 v[116:119], v4 offset:8192
  ds_read_b128 v[120:123], v5 offset:0
  ds_read_b128 v[124:127], v5 offset:8192
  s_waitcnt lgkmcnt(0)
  s_branch L_b_go
L_b_first:
  s_mov_b32 s98, 0
  v_max3_f32 v19, v64, v65, v66
  v_max3_f32 v19, v19, v67, v68
  v_max3_f32 v19, v19, v69, v70
  v_max3_f32 v19, v19, v71, v72
  v_max3_f32 v19, v19, v73, v74
  v_max3_f32 v19, v19, v75, v76
  v_max3_f32 v19, v19, v77, v78
  v_max3_f32 v19, v19, v79, v80
  v_max3_f32 v19, v19, v81, v82
  v_max3_f32 v19, v19, v83, v84
  v_max3_f32 v19, v19, v85, v86
  v_max3_f32 v19, v19, v87, v88
  v_max3_f32 v19, v19, v89, v90
  v_max3_f32 v19, v19, v91, v92
  v_max3_f32 v19, v19, v93, v94
  v_max_f32 v19, v19, v95
  v_mov_b32 v20, v19
  s_nop 1
  v_permlane32_swap_b32 v19, v20
  v_max_f32 v19, v19, v20
  s_branch L_b_shift
L_b_fallback:
  v_max3_f32 v19, v64, v65, v66
  v_max3_f32 v19, v19, v67, v68
  v_max3_f32 v19, v19, v69, v70
  v_max3_f32 v19, v19, v71, v72
  v_max3_f32 v19, v19, v73, v74
  v_max3_f32 v19, v19, v75, v76
  v_max3_f32 v19, v19, v77, v78
  v_max3_f32 v19, v19, v79, v80
  v_max3_f32 v19, v19, v81, v82
  v_max3_f32 v19, v19, v83, v84
  v_max3_f32 v19, v19, v85, v86
  v_max3_f32 v19, v19, v87, v88
  v_max3_f32 v19, v19, v89, v90
  v_max3_f32 v19, v19, v91, v92
  v_max3_f32 v19, v19, v93, v94
  v_max_f32 v19, v19, v95
  v_mov_b32 v20, v19
  s_nop 1
  v_permlane32_swap_b32 v19, v20
  v_max3_f32 v19, v19, v20, 0
  v_exp_f32 v20, -v19
  s_nop 0
  v_mul_f32 v17, v17, v20
  v_mul_f32 v192, v192, v20
  v_mul_f32 v193, v193, v20
  v_mul_f32 v194, v194, v20
  v_mul_f32 v195, v195, v20
  v_mul_f32 v196, v196, v20
  v_mul_f32 v197, v197, v20
  v_mul_f32 v198, v198, v20
  v_mul_f32 v199, v199, v20
  v_mul_f32 v200, v200, v20
  v_mul_f32 v201, v201, v20
  v_mul_f32 v202, v202, v20
  v_mul_f32 v203, v203, v20
  v_mul_f32 v204, v204, v20
  v_mul_f32 v205, v205, v20
  v_mul_f32 v206, v206, v20
  v_mul_f32 v207, v207, v20
  v_mul_f32 v208, v208, v20
  v_mul_f32 v209, v209, v20
  v_mul_f32 v210, v210, v20
  v_mul_f32 v211, v211, v20
  v_mul_f32 v212, v212, v20
  v_mul_f32 v213, v213, v20
  v_mul_f32 v214, v214, v20
  v_mul_f32 v215, v215, v20
  v_mul_f32 v216, v216, v20
  v_mul_f32 v217, v217, v20
  v_mul_f32 v218, v218, v20
  v_mul_f32 v219, v219, v20
  v_mul_f32 v220, v220, v20
  v_mul_f32 v221, v221, v20
  v_mul_f32 v222, v222, v20
  v_mul_f32 v223, v223, v20
  v_mul_f32 v224, v224, v20
  v_mul_f32 v225, v225, v20
  v_mul_f32 v226, v226, v20
  v_mul_f32 v227, v227, v20
  v_mul_f32 v228, v228, v20
  v_mul_f32 v229, v229, v20
  v_mul_f32 v230, v230, v20
  v_mul_f32 v231, v231, v20
  v_mul_f32 v232, v232, v20
  v_mul_f32 v233, v233, v20
  v_mul_f32 v234, v234, v20
  v_mul_f32 v235, v235, v20
  v_mul_f32 v236, v236, v20
  v_mul_f32 v237, v237, v20
  v_mul_f32 v238, v238, v20
  v_mul_f32 v239, v239, v20
  v_mul_f32 v240, v240, v20
  v_mul_f32 v241, v241, v20
  v_mul_f32 v242, v242, v20
  v_mul_f32 v243, v243, v20
  v_mul_f32 v244, v244, v20
  v_mul_f32 v245, v245, v20
  v_mul_f32 v246, v246, v20
  v_mul_f32 v247, v247, v20
  v_mul_f32 v248, v248, v20
  v_mul_f32 v249, v249, v20
  v_mul_f32 v250, v250, v20
  v_mul_f32 v251, v251, v20
  v_mul_f32 v252, v252, v20
  v_mul_f32 v253, v253, v20
  v_mul_f32 v254, v254, v20
  v_mul_f32 v255, v255, v20
L_b_shift:
  v_sub_f32 v64, v64, v19
  v_sub_f32 v65, v65, v19
  v_sub_f32 v66, v66, v19
  v_sub_f32 v67, v67, v19
  v_sub_f32 v68, v68, v19
  v_sub_f32 v69, v69, v19
  v_sub_f32 v70, v70, v19
  v_sub_f32 v71, v71, v19
  v_sub_f32 v72, v72, v19
  v_sub_f32 v73, v73, v19
  v_sub_f32 v74, v74, v19
  v_sub_f32 v75, v75, v19
  v_sub_f32 v76, v76, v19
  v_sub_f32 v77, v77, v19
  v_sub_f32 v78, v78, v19
  v_sub_f32 v79, v79, v19
  v_sub_f32 v80, v80, v19
  v_sub_f32 v81, v81, v19
  v_sub_f32 v82, v82, v19
  v_sub_f32 v83, v83, v19
  v_sub_f32 v84, v84, v19
  v_sub_f32 v85, v85, v19
  v_sub_f32 v86, v86, v19
  v_sub_f32 v87, v87, v19
  v_sub_f32 v88, v88, v19
  v_sub_f32 v89, v89, v19
  v_sub_f32 v90, v90, v19
  v_sub_f32 v91, v91, v19
  v_sub_f32 v92, v92, v19
  v_sub_f32 v93, v93, v19
  v_sub_f32 v94, v94, v19
  v_sub_f32 v95, v95, v19
  v_sub_f32 v136, v136, v19
  v_sub_f32 v137, v137, v19
  v_sub_f32 v138, v138, v19
  v_sub_f32 v139, v139, v19
  v_sub_f32 v140, v140, v19
  v_sub_f32 v141, v141, v19
  v_sub_f32 v142, v142, v19
  v_sub_f32 v143, v143, v19
  v_sub_f32 v144, v144, v19
  v_sub_f32 v145, v145, v19
  v_sub_f32 v146, v146, v19
  v_sub_f32 v147, v147, v19
  v_sub_f32 v148, v148, v19
  v_sub_f32 v149, v149, v19
  v_sub_f32 v150, v150, v19
  v_sub_f32 v151, v151, v19
  v_exp_f32 v184, v64
  v_exp_f32 v185, v65
  v_exp_f32 v186, v66
  v_exp_f32 v187, v67
  v_cvt_pk_bf16_f32 v96, v184, v185
  v_mov_b32 v18, v184
  v_mov_b32 v27, v185
  v_exp_f32 v188, v68
  v_exp_f32 v189, v69
  v_cvt_pk_bf16_f32 v97, v186, v187
  v_add_f32 v18, v18, v186
  v_add_f32 v27, v27, v187
  v_exp_f32 v190, v70
  v_exp_f32 v191, v71
  v_cvt_pk_bf16_f32 v98, v188, v189
  v_add_f32 v18, v18, v188
  v_add_f32 v27, v27, v189
  v_exp_f32 v184, v72
  v_exp_f32 v185, v73
  v_cvt_pk_bf16_f32 v99, v190, v191
  v_add_f32 v18, v18, v190
  v_add_f32 v27, v27, v191
  v_exp_f32 v186, v74
  v_exp_f32 v187, v75
  v_cvt_pk_bf16_f32 v100, v184, v185
  v_add_f32 v18, v18, v184
  v_add_f32 v27, v27, v185
  v_exp_f32 v188, v76
  v_exp_f32 v189, v77
  v_cvt_pk_bf16_f32 v101, v186, v187
  v_add_f32 v18, v18, v186
  v_add_f32 v27, v27, v187
  v_exp_f32 v190, v78
  v_exp_f32 v191, v79
  v_cvt_pk_bf16_f32 v102, v188, v189
  v_add_f32 v18, v18, v188
  v_add_f32 v27, v27, v189
  v_exp_f32 v184, v80
  v_exp_f32 v185, v81
  v_cvt_pk_bf16_f32 v103, v190, v191
  v_add_f32 v18, v18, v190
  v_add_f32 v27, v27, v191
  v_exp_f32 v186, v82
  v_exp_f32 v187, v83
  v_cvt_pk_bf16_f32 v104, v184, v185
  v_add_f32 v18, v18, v184
  v_add_f32 v27, v27, v185
  v_exp_f32 v188, v84
  v_exp_f32 v189, v85
  v_cvt_pk_bf16_f32 v105, v186, v187
  v_add_f32 v18, v18, v186
  v_add_f32 v27, v27, v187
  v_exp_f32 v190, v86
  v_exp_f32 v191, v87
  v_cvt_pk_bf16_f32 v106, v188, v189
  v_add_f32 v18, v18, v188
  v_add_f32 v27, v27, v189
  v_exp_f32 v184, v88
  v_exp_f32 v185, v89
  v_cvt_pk_bf16_f32 v107, v190, v191
  v_add_f32 v18, v18, v190
  v_add_f32 v27, v27, v191
  v_exp_f32 v186, v90
  v_exp_f32 v187, v91
  v_cvt_pk_bf16_f32 v108, v184, v185
  v_add_f32 v18, v18, v184
  v_add_f32 v27, v27, v185
  v_exp_f32 v188, v92
  v_exp_f32 v189, v93
  v_cvt_pk_bf16_f32 v109, v186, v187
  v_add_f32 v18, v18, v186
  v_add_f32 v27, v27, v187
  v_exp_f32 v190, v94
  v_exp_f32 v191, v95
  v_cvt_pk_bf16_f32 v110, v188, v189
  v_add_f32 v18, v18, v188
  v_add_f32 v27, v27, v189
  s_nop 0
  v_cvt_pk_bf16_f32 v111, v190, v191
  v_add_f32 v18, v18, v190
  v_add_f32 v27, v27, v191
  s_nop 0
  v_add_f32 v18, v18, v27
  s_branch L_b_cont
L_a_start:
  s_lshl_b32 s65, s2, 15
  s_add_u32 s60, s52, 0x0
  s_addc_u32 s61, s53, 0
  s_add_u32 s60, s60, s65
  s_addc_u32 s61, s61, 0
  s_sub_u32 s62, 0x800000, s65
  s_mov_b32 s63, 0x00020000
  s_lshl_b32 s65, s2, 13
  s_add_u32 s52, s40, 0x0
  s_addc_u32 s53, s41, 0
  s_add_u32 s52, s52, s65
  s_addc_u32 s53, s53, 0
  s_sub_u32 s54, 0x200000, s65
  s_mov_b32 s55, 0x00020000
  s_add_u32 s4, s58, 0x0
  s_addc_u32 s5, s59, 0
  s_mov_b32 s6, 0x400000
  s_mov_b32 s7, 0x00020000
  s_add_u32 s8, s58, 0x400000
  s_addc_u32 s9, s59, 0
  s_mov_b32 s10, 0x20000
  s_mov_b32 s11, 0x00020000
  s_add_u32 s12, s58, 0x440000
  s_addc_u32 s13, s59, 0
  s_mov_b32 s14, 0x20000
  s_mov_b32 s15, 0x00020000
  s_add_u32 s16, s58, 0x3800000
  s_addc_u32 s17, s59, 0
  s_mov_b32 s18, 0x400000
  s_mov_b32 s19, 0x00020000
  s_lshl_b32 s22, s2, 2
  s_add_u32 s22, s22, s20
  s_sub_u32 s22, s22, 4
  s_lshl_b32 s22, s22, 6
  v_and_b32 v15, 31, v1
  v_lshrrev_b32 v7, 5, v1
  v_add_u32 v14, s22, v15
  v_lshlrev_b32 v4, 6, v14
  v_lshl_add_u32 v4, v7, 4, v4
  buffer_load_dwordx4 v[16:19], v4, s[4:7], 0 offen offset:0
  buffer_load_dwordx4 v[20:23], v4, s[4:7], 0 offen offset:32
  buffer_load_dwordx4 v[24:27], v4, s[4:7], 0 offen offset:2048
  buffer_load_dwordx4 v[28:31], v4, s[4:7], 0 offen offset:2080
  v_lshlrev_b32 v2, 6, v15
  v_lshl_add_u32 v2, v7, 4, v2
  v_lshlrev_b32 v3, 12, v15
  v_lshl_add_u32 v3, v7, 4, v3
  s_mov_b32 s28, 0
  s_mov_b32 s29, 0
  buffer_load_dwordx4 v[192:195], v2, s[8:11], s28 offen offset:0
  buffer_load_dwordx4 v[196:199], v2, s[8:11], s28 offen offset:32
  buffer_load_dwordx4 v[200:203], v2, s[8:11], s28 offen offset:2048
  buffer_load_dwordx4 v[204:207], v2, s[8:11], s28 offen offset:2080
  s_add_u32 s28, s28, 4096
  buffer_load_dwordx4 v[208:211], v2, s[8:11], s28 offen offset:0
  buffer_load_dwordx4 v[212:215], v2, s[8:11], s28 offen offset:32
  buffer_load_dwordx4 v[216:219], v2, s[8:11], s28 offen offset:2048
  buffer_load_dwordx4 v[220:223], v2, s[8:11], s28 offen offset:2080
  s_add_u32 s28, s28, 4096
  buffer_load_dwordx4 v[224:227], v3, s[12:15], s29 offen offset:0
  buffer_load_dwordx4 v[228:231], v3, s[12:15], s29 offen offset:32
  buffer_load_dwordx4 v[232:235], v3, s[12:15], s29 offen offset:64
  buffer_load_dwordx4 v[236:239], v3, s[12:15], s29 offen offset:96
  s_add_u32 s29, s29, 128
  s_sub_u32 s22, s20, 4
  s_lshl_b32 s22, s22, 10
  v_lshlrev_b32 v15, 4, v1
  v_add_u32 v15, s22, v15
  v_mov_b32 v32, 0
  v_mov_b32 v64, 0
  v_mov_b32 v33, 0
  v_mov_b32 v65, 0
  v_mov_b32 v34, 0
  v_mov_b32 v66, 0
  v_mov_b32 v35, 0
  v_mov_b32 v67, 0
  v_mov_b32 v36, 0
  v_mov_b32 v68, 0
  v_mov_b32 v37, 0
  v_mov_b32 v69, 0
  v_mov_b32 v38, 0
  v_mov_b32 v70, 0
  v_mov_b32 v39, 0
  v_mov_b32 v71, 0
  v_mov_b32 v40, 0
  v_mov_b32 v72, 0
  v_mov_b32 v41, 0
  v_mov_b32 v73, 0
  v_mov_b32 v42, 0
  v_mov_b32 v74, 0
  v_mov_b32 v43, 0
  v_mov_b32 v75, 0
  v_mov_b32 v44, 0
  v_mov_b32 v76, 0
  v_mov_b32 v45, 0
  v_mov_b32 v77, 0
  v_mov_b32 v46, 0
  v_mov_b32 v78, 0
  v_mov_b32 v47, 0
  v_mov_b32 v79, 0
  v_mov_b32 v48, 0
  v_mov_b32 v80, 0
  v_mov_b32 v49, 0
  v_mov_b32 v81, 0
  v_mov_b32 v50, 0
  v_mov_b32 v82, 0
  v_mov_b32 v51, 0
  v_mov_b32 v83, 0
  v_mov_b32 v52, 0
  v_mov_b32 v84, 0
  v_mov_b32 v53, 0
  v_mov_b32 v85, 0
  v_mov_b32 v54, 0
  v_mov_b32 v86, 0
  v_mov_b32 v55, 0
  v_mov_b32 v87, 0
  v_mov_b32 v56, 0
  v_mov_b32 v88, 0
  v_mov_b32 v57, 0
  v_mov_b32 v89, 0
  v_mov_b32 v58, 0
  v_mov_b32 v90, 0
  v_mov_b32 v59, 0
  v_mov_b32 v91, 0
  v_mov_b32 v60, 0
  v_mov_b32 v92, 0
  v_mov_b32 v61, 0
  v_mov_b32 v93, 0
  v_mov_b32 v62, 0
  v_mov_b32 v94, 0
  v_mov_b32 v63, 0
  v_mov_b32 v95, 0
  v_mov_b32 v112, 0
  v_mov_b32 v240, 0
  v_mov_b32 v113, 0
  v_mov_b32 v241, 0
  v_mov_b32 v114, 0
  v_mov_b32 v242, 0
  v_mov_b32 v115, 0
  v_mov_b32 v243, 0
  v_mov_b32 v116, 0
  v_mov_b32 v244, 0
  v_mov_b32 v117, 0
  v_mov_b32 v245, 0
  v_mov_b32 v118, 0
  v_mov_b32 v246, 0
  v_mov_b32 v119, 0
  v_mov_b32 v247, 0
  v_mov_b32 v120, 0
  v_mov_b32 v248, 0
  v_mov_b32 v121, 0
  v_mov_b32 v249, 0
  v_mov_b32 v122, 0
  v_mov_b32 v250, 0
  v_mov_b32 v123, 0
  v_mov_b32 v251, 0
  v_mov_b32 v124, 0
  v_mov_b32 v252, 0
  v_mov_b32 v125, 0
  v_mov_b32 v253, 0
  v_mov_b32 v126, 0
  v_mov_b32 v254, 0
  v_mov_b32 v127, 0
  v_mov_b32 v255, 0
  v_mov_b32 v5, 0
  v_mov_b32 v6, 0
  s_mov_b32 s24, 0xbf800000
  s_mov_b32 s26, 0xff800000
  s_mov_b32 s25, 0xbf800000
  s_mov_b32 s27, 0xff800000
  s_mov_b32 s21, 0
  s_waitcnt vmcnt(0)
  v_mfma_f32_32x32x16_bf16 v[128:143], v[192:195], v[16:19], v[32:47]
  v_mfma_f32_32x32x16_bf16 v[144:159], v[200:203], v[16:19], v[32:47]
  v_mfma_f32_32x32x16_bf16 v[128:143], v[196:199], v[20:23], v[128:143]
  v_mfma_f32_32x32x16_bf16 v[144:159], v[204:207], v[20:23], v[144:159]
  s_sub_u32 s66, s20, 4
  s_lshl_b32 s66, s66, 10
  s_add_u32 m0, s66, 0x18000
  s_mov_b32 s66, 0
  buffer_load_dwordx4 v15, s[60:63], s66 offen lds
  s_mov_b32 s66, 4096
  buffer_load_dwordx4 v15, s[60:63], s66 offen lds
  s_mov_b32 s66, 8192
  buffer_load_dwordx4 v15, s[60:63], s66 offen lds
  s_mov_b32 s66, 12288
  buffer_load_dwordx4 v15, s[60:63], s66 offen lds
  s_mov_b32 s66, 16384
  buffer_load_dwordx4 v15, s[60:63], s66 offen lds
  s_mov_b32 s66, 20480
  buffer_load_dwordx4 v15, s[60:63], s66 offen lds
  s_mov_b32 s66, 24576
  buffer_load_dwordx4 v15, s[60:63], s66 offen lds
  s_mov_b32 s66, 28672
  buffer_load_dwordx4 v15, s[60:63], s66 offen lds
  s_mov_b32 s66, 0
  buffer_load_dwordx4 v15, s[52:55], s66 offen lds
  s_mov_b32 s66, 4096
  buffer_load_dwordx4 v15, s[52:55], s66 offen lds
  s_nop 7
L_a_loop:
  s_barrier
L_a_loop_nb:
  v_exp_f32 v8, v128
  v_exp_f32 v9, v129
  v_exp_f32 v10, v130
  v_exp_f32 v11, v131
  v_cvt_pk_bf16_f32 v96, v8, v9
  v_mov_b32 v7, v8
  v_mov_b32 v14, v9
  v_exp_f32 v12, v132
  v_exp_f32 v13, v133
  v_cvt_pk_bf16_f32 v97, v10, v11
  v_add_f32 v7, v7, v10
  v_add_f32 v14, v14, v11
  v_exp_f32 v8, v134
  v_exp_f32 v9, v135
  v_cvt_pk_bf16_f32 v98, v12, v13
  v_add_f32 v7, v7, v12
  v_add_f32 v14, v14, v13
  v_exp_f32 v10, v136
  v_exp_f32 v11, v137
  v_cvt_pk_bf16_f32 v99, v8, v9
  v_add_f32 v7, v7, v8
  v_add_f32 v14, v14, v9
  v_exp_f32 v12, v138
  v_exp_f32 v13, v139
  v_cvt_pk_bf16_f32 v100, v10, v11
  v_add_f32 v7, v7, v10
  v_add_f32 v14, v14, v11
  v_exp_f32 v8, v140
  v_exp_f32 v9, v141
  v_cvt_pk_bf16_f32 v101, v12, v13
  v_add_f32 v7, v7, v12
  v_add_f32 v14, v14, v13
  v_exp_f32 v10, v142
  v_exp_f32 v11, v143
  v_cvt_pk_bf16_f32 v102, v8, v9
  v_add_f32 v7, v7, v8
  v_add_f32 v14, v14, v9
  v_exp_f32 v12, v144
  v_exp_f32 v13, v145
  v_cvt_pk_bf16_f32 v103, v10, v11
  v_add_f32 v7, v7, v10
  v_add_f32 v14, v14, v11
  v_exp_f32 v8, v146
  v_exp_f32 v9, v147
  v_cvt_pk_bf16_f32 v104, v12, v13
  v_add_f32 v7, v7, v12
  v_add_f32 v14, v14, v13
  v_exp_f32 v10, v148
  v_exp_f32 v11, v149
  v_cvt_pk_bf16_f32 v105, v8, v9
  v_add_f32 v7, v7, v8
  v_add_f32 v14, v14, v9
  v_exp_f32 v12, v150
  v_exp_f32 v13, v151
  v_cvt_pk_bf16_f32 v106, v10, v11
  v_add_f32 v7, v7, v10
  v_add_f32 v14, v14, v11
  v_exp_f32 v8, v152
  v_exp_f32 v9, v153
  v_cvt_pk_bf16_f32 v107, v12, v13
  v_add_f32 v7, v7, v12
  v_add_f32 v14, v14, v13
  v_exp_f32 v10, v154
  v_exp_f32 v11, v155
  v_cvt_pk_bf16_f32 v108, v8, v9
  v_add_f32 v7, v7, v8
  v_add_f32 v14, v14, v9
  v_exp_f32 v12, v156
  v_exp_f32 v13, v157
  v_cvt_pk_bf16_f32 v109, v10, v11
  v_add_f32 v7, v7, v10
  v_add_f32 v14, v14, v11
  v_exp_f32 v8, v158
  v_exp_f32 v9, v159
  v_cvt_pk_bf16_f32 v110, v12, v13
  v_add_f32 v7, v7, v12
  v_add_f32 v14, v14, v13
  s_nop 0
  v_cvt_pk_bf16_f32 v111, v8, v9
  v_add_f32 v7, v7, v8
  v_add_f32 v14, v14, v9
  s_nop 0
  v_add_f32 v7, v7, v14
  v_cmp_nge_f32 vcc, s24, v7
  s_nop 0
  s_cbranch_vccnz L_afb_27
L_acont_28:
  v_add_f32 v5, v5, v7
  s_waitcnt vmcnt(0)
  v_mfma_f32_32x32x16_bf16 v[160:175], v[192:195], v[24:27], v[48:63]
  v_mfma_f32_32x32x16_bf16 v[176:191], v[200:203], v[24:27], v[48:63]
  v_mfma_f32_32x32x16_bf16 v[160:175], v[196:199], v[28:31], v[160:175]
  v_mfma_f32_32x32x16_bf16 v[176:191], v[204:207], v[28:31], v[176:191]
  v_mfma_f32_32x32x16_bf16 v[80:95], v[240:243], v[112:115], v[80:95]
  v_mfma_f32_32x32x16_bf16 v[80:95], v[244:247], v[116:119], v[80:95]
  v_mfma_f32_32x32x16_bf16 v[80:95], v[248:251], v[120:123], v[80:95]
  v_mfma_f32_32x32x16_bf16 v[80:95], v[252:255], v[124:127], v[80:95]
  v_mfma_f32_32x32x16_bf16 v[64:79], v[224:227], v[96:99], v[64:79]
  v_mfma_f32_32x32x16_bf16 v[64:79], v[228:231], v[100:103], v[64:79]
  v_mfma_f32_32x32x16_bf16 v[64:79], v[232:235], v[104:107], v[64:79]
  v_mfma_f32_32x32x16_bf16 v[64:79], v[236:239], v[108:111], v[64:79]
  v_mfma_f32_32x32x16_bf16 v[128:143], v[208:211], v[16:19], v[32:47]
  v_mfma_f32_32x32x16_bf16 v[144:159], v[216:219], v[16:19], v[32:47]
  v_mfma_f32_32x32x16_bf16 v[128:143], v[212:215], v[20:23], v[128:143]
  v_mfma_f32_32x32x16_bf16 v[144:159], v[220:223], v[20:23], v[144:159]
  v_exp_f32 v8, v160
  v_exp_f32 v9, v161
  buffer_load_dwordx4 v[192:195], v2, s[8:11], s28 offen offset:0
  v_exp_f32 v10, v162
  v_exp_f32 v11, v163
  buffer_load_dwordx4 v[196:199], v2, s[8:11], s28 offen offset:32
  v_cvt_pk_bf16_f32 v112, v8, v9
  v_mov_b32 v7, v8
  v_mov_b32 v14, v9
  v_exp_f32 v12, v164
  v_exp_f32 v13, v165
  buffer_load_dwordx4 v[200:203], v2, s[8:11], s28 offen offset:2048
  v_cvt_pk_bf16_f32 v113, v10, v11
  v_add_f32 v7, v7, v10
  v_add_f32 v14, v14, v11
  v_exp_f32 v8, v166
  v_exp_f32 v9, v167
  buffer_load_dwordx4 v[204:207], v2, s[8:11], s28 offen offset:2080
  v_cvt_pk_bf16_f32 v114, v12, v13
  v_add_f32 v7, v7, v12
  v_add_f32 v14, v14, v13
  v_exp_f32 v10, v168
  v_exp_f32 v11, v169
  s_add_u32 s28, s28, 4096
  v_cvt_pk_bf16_f32 v115, v8, v9
  v_add_f32 v7, v7, v8
  v_add_f32 v14, v14, v9
  v_exp_f32 v12, v170
  v_exp_f32 v13, v171
  buffer_load_dwordx4 v[240:243], v3, s[12:15], s29 offen offset:0
  v_cvt_pk_bf16_f32 v116, v10, v11
  v_add_f32 v7, v7, v10
  v_add_f32 v14, v14, v11
  v_exp_f32 v8, v172
  v_exp_f32 v9, v173
  buffer_load_dwordx4 v[244:247], v3, s[12:15], s29 offen offset:32
  v_cvt_pk_bf16_f32 v117, v12, v13
  v_add_f32 v7, v7, v12
  v_add_f32 v14, v14, v13
  v_exp_f32 v10, v174
  v_exp_f32 v11, v175
  buffer_load_dwordx4 v[248:251], v3, s[12:15], s29 offen offset:64
  v_cvt_pk_bf16_f32 v118, v8, v9
  v_add_f32 v7, v7, v8
  v_add_f32 v14, v14, v9
  v_exp_f32 v12, v176
  v_exp_f32 v13, v177
  buffer_load_dwordx4 v[252:255], v3, s[12:15], s29 offen offset:96
  v_cvt_pk_bf16_f32 v119, v10, v11
  v_add_f32 v7, v7, v10
  v_add_f32 v14, v14, v11
  v_exp_f32 v8, v178
  v_exp_f32 v9, v179
  s_add_u32 s29, s29, 128
  v_cvt_pk_bf16_f32 v120, v12, v13
  v_add_f32 v7, v7, v12
  v_add_f32 v14, v14, v13
  v_exp_f32 v10, v180
  v_exp_f32 v11, v181
  v_cvt_pk_bf16_f32 v121, v8, v9
  v_add_f32 v7, v7, v8
  v_add_f32 v14, v14, v9
  v_exp_f32 v12, v182
  v_exp_f32 v13, v183
  v_cvt_pk_bf16_f32 v122, v10, v11
  v_add_f32 v7, v7, v10
  v_add_f32 v14, v14, v11
  v_exp_f32 v8, v184
  v_exp_f32 v9, v185
  v_cvt_pk_bf16_f32 v123, v12, v13
  v_add_f32 v7, v7, v12
  v_add_f32 v14, v14, v13
  v_exp_f32 v10, v186
  v_exp_f32 v11, v187
  v_cvt_pk_bf16_f32 v124, v8, v9
  v_add_f32 v7, v7, v8
  v_add_f32 v14, v14, v9
  v_exp_f32 v12, v188
  v_exp_f32 v13, v189
  v_cvt_pk_bf16_f32 v125, v10, v11
  v_add_f32 v7, v7, v10
  v_add_f32 v14, v14, v11
  v_exp_f32 v8, v190
  v_exp_f32 v9, v191
  v_cvt_pk_bf16_f32 v126, v12, v13
  v_add_f32 v7, v7, v12
  v_add_f32 v14, v14, v13
  s_nop 0
  v_cvt_pk_bf16_f32 v127, v8, v9
  v_add_f32 v7, v7, v8
  v_add_f32 v14, v14, v9
  s_nop 0
  v_add_f32 v7, v7, v14
  v_cmp_nge_f32 vcc, s25, v7
  s_nop 0
  s_cbranch_vccnz L_afb_29
L_acont_30:
  v_add_f32 v6, v6, v7
  s_barrier
  v_exp_f32 v8, v128
  v_exp_f32 v9, v129
  v_exp_f32 v10, v130
  v_exp_f32 v11, v131
  v_cvt_pk_bf16_f32 v96, v8, v9
  v_mov_b32 v7, v8
  v_mov_b32 v14, v9
  v_exp_f32 v12, v132
  v_exp_f32 v13, v133
  v_cvt_pk_bf16_f32 v97, v10, v11
  v_add_f32 v7, v7, v10
  v_add_f32 v14, v14, v11
  v_exp_f32 v8, v134
  v_exp_f32 v9, v135
  v_cvt_pk_bf16_f32 v98, v12, v13
  v_add_f32 v7, v7, v12
  v_add_f32 v14, v14, v13
  v_exp_f32 v10, v136
  v_exp_f32 v11, v137
  v_cvt_pk_bf16_f32 v99, v8, v9
  v_add_f32 v7, v7, v8
  v_add_f32 v14, v14, v9
  v_exp_f32 v12, v138
  v_exp_f32 v13, v139
  v_cvt_pk_bf16_f32 v100, v10, v11
  v_add_f32 v7, v7, v10
  v_add_f32 v14, v14, v11
  v_exp_f32 v8, v140
  v_exp_f32 v9, v141
  v_cvt_pk_bf16_f32 v101, v12, v13
  v_add_f32 v7, v7, v12
  v_add_f32 v14, v14, v13
  v_exp_f32 v10, v142
  v_exp_f32 v11, v143
  v_cvt_pk_bf16_f32 v102, v8, v9
  v_add_f32 v7, v7, v8
  v_add_f32 v14, v14, v9
  v_exp_f32 v12, v144
  v_exp_f32 v13, v145
  v_cvt_pk_bf16_f32 v103, v10, v11
  v_add_f32 v7, v7, v10
  v_add_f32 v14, v14, v11
  v_exp_f32 v8, v146
  v_exp_f32 v9, v147
  v_cvt_pk_bf16_f32 v104, v12, v13
  v_add_f32 v7, v7, v12
  v_add_f32 v14, v14, v13
  v_exp_f32 v10, v148
  v_exp_f32 v11, v149
  v_cvt_pk_bf16_f32 v105, v8, v9
  v_add_f32 v7, v7, v8
  v_add_f32 v14, v14, v9
  v_exp_f32 v12, v150
  v_exp_f32 v13, v151
  v_cvt_pk_bf16_f32 v106, v10, v11
  v_add_f32 v7, v7, v10
  v_add_f32 v14, v14, v11
  v_exp_f32 v8, v152
  v_exp_f32 v9, v153
  v_cvt_pk_bf16_f32 v107, v12, v13
  v_add_f32 v7, v7, v12
  v_add_f32 v14, v14, v13
  v_exp_f32 v10, v154
  v_exp_f32 v11, v155
  v_cvt_pk_bf16_f32 v108, v8, v9
  v_add_f32 v7, v7, v8
  v_add_f32 v14, v14, v9
  v_exp_f32 v12, v156
  v_exp_f32 v13, v157
  v_cvt_pk_bf16_f32 v109, v10, v11
  v_add_f32 v7, v7, v10
  v_add_f32 v14, v14, v11
  v_exp_f32 v8, v158
  v_exp_f32 v9, v159
  v_cvt_pk_bf16_f32 v110, v12, v13
  v_add_f32 v7, v7, v12
  v_add_f32 v14, v14, v13
  s_nop 0
  v_cvt_pk_bf16_f32 v111, v8, v9
  v_add_f32 v7, v7, v8
  v_add_f32 v14, v14, v9
  s_nop 0
  v_add_f32 v7, v7, v14
  v_cmp_nge_f32 vcc, s24, v7
  s_nop 0
  s_cbranch_vccnz L_afb_31
L_acont_32:
  v_add_f32 v5, v5, v7
  s_waitcnt vmcnt(0)
  v_mfma_f32_32x32x16_bf16 v[160:175], v[208:211], v[24:27], v[48:63]
  v_mfma_f32_32x32x16_bf16 v[176:191], v[216:219], v[24:27], v[48:63]
  v_mfma_f32_32x32x16_bf16 v[160:175], v[212:215], v[28:31], v[160:175]
  v_mfma_f32_32x32x16_bf16 v[176:191], v[220:223], v[28:31], v[176:191]
  v_mfma_f32_32x32x16_bf16 v[80:95], v[224:227], v[112:115], v[80:95]
  v_mfma_f32_32x32x16_bf16 v[80:95], v[228:231], v[116:119], v[80:95]
  v_mfma_f32_32x32x16_bf16 v[80:95], v[232:235], v[120:123], v[80:95]
  v_mfma_f32_32x32x16_bf16 v[80:95], v[236:239], v[124:127], v[80:95]
  v_mfma_f32_32x32x16_bf16 v[64:79], v[240:243], v[96:99], v[64:79]
  v_mfma_f32_32x32x16_bf16 v[64:79], v[244:247], v[100:103], v[64:79]
  v_mfma_f32_32x32x16_bf16 v[64:79], v[248:251], v[104:107], v[64:79]
  v_mfma_f32_32x32x16_bf16 v[64:79], v[252:255], v[108:111], v[64:79]
  v_mfma_f32_32x32x16_bf16 v[128:143], v[192:195], v[16:19], v[32:47]
  v_mfma_f32_32x32x16_bf16 v[144:159], v[200:203], v[16:19], v[32:47]
  v_mfma_f32_32x32x16_bf16 v[128:143], v[196:199], v[20:23], v[128:143]
  v_mfma_f32_32x32x16_bf16 v[144:159], v[204:207], v[20:23], v[144:159]
  v_exp_f32 v8, v160
  v_exp_f32 v9, v161
  buffer_load_dwordx4 v[208:211], v2, s[8:11], s28 offen offset:0
  v_exp_f32 v10, v162
  v_exp_f32 v11, v163
  buffer_load_dwordx4 v[212:215], v2, s[8:11], s28 offen offset:32
  v_cvt_pk_bf16_f32 v112, v8, v9
  v_mov_b32 v7, v8
  v_mov_b32 v14, v9
  v_exp_f32 v12, v164
  v_exp_f32 v13, v165
  buffer_load_dwordx4 v[216:219], v2, s[8:11], s28 offen offset:2048
  v_cvt_pk_bf16_f32 v113, v10, v11
  v_add_f32 v7, v7, v10
  v_add_f32 v14, v14, v11
  v_exp_f32 v8, v166
  v_exp_f32 v9, v167
  buffer_load_dwordx4 v[220:223], v2, s[8:11], s28 offen offset:2080
  v_cvt_pk_bf16_f32 v114, v12, v13
  v_add_f32 v7, v7, v12
  v_add_f32 v14, v14, v13
  v_exp_f32 v10, v168
  v_exp_f32 v11, v169
  s_add_u32 s28, s28, 4096
  v_cvt_pk_bf16_f32 v115, v8, v9
  v_add_f32 v7, v7, v8
  v_add_f32 v14, v14, v9
  v_exp_f32 v12, v170
  v_exp_f32 v13, v171
  buffer_load_dwordx4 v[224:227], v3, s[12:15], s29 offen offset:0
  v_cvt_pk_bf16_f32 v116, v10, v11
  v_add_f32 v7, v7, v10
  v_add_f32 v14, v14, v11
  v_exp_f32 v8, v172
  v_exp_f32 v9, v173
  buffer_load_dwordx4 v[228:231], v3, s[12:15], s29 offen offset:32
  v_cvt_pk_bf16_f32 v117, v12, v13
  v_add_f32 v7, v7, v12
  v_add_f32 v14, v14, v13
  v_exp_f32 v10, v174
  v_exp_f32 v11, v175
  buffer_load_dwordx4 v[232:235], v3, s[12:15], s29 offen offset:64
  v_cvt_pk_bf16_f32 v118, v8, v9
  v_add_f32 v7, v7, v8
  v_add_f32 v14, v14, v9
  v_exp_f32 v12, v176
  v_exp_f32 v13, v177
  buffer_load_dwordx4 v[236:239], v3, s[12:15], s29 offen offset:96
  v_cvt_pk_bf16_f32 v119, v10, v11
  v_add_f32 v7, v7, v10
  v_add_f32 v14, v14, v11
  v_exp_f32 v8, v178
  v_exp_f32 v9, v179
  s_add_u32 s29, s29, 128
  v_cvt_pk_bf16_f32 v120, v12, v13
  v_add_f32 v7, v7, v12
  v_add_f32 v14, v14, v13
  v_exp_f32 v10, v180
  v_exp_f32 v11, v181
  v_cvt_pk_bf16_f32 v121, v8, v9
  v_add_f32 v7, v7, v8
  v_add_f32 v14, v14, v9
  v_exp_f32 v12, v182
  v_exp_f32 v13, v183
  v_cvt_pk_bf16_f32 v122, v10, v11
  v_add_f32 v7, v7, v10
  v_add_f32 v14, v14, v11
  v_exp_f32 v8, v184
  v_exp_f32 v9, v185
  v_cvt_pk_bf16_f32 v123, v12, v13
  v_add_f32 v7, v7, v12
  v_add_f32 v14, v14, v13
  v_exp_f32 v10, v186
  v_exp_f32 v11, v187
  v_cvt_pk_bf16_f32 v124, v8, v9
  v_add_f32 v7, v7, v8
  v_add_f32 v14, v14, v9
  v_exp_f32 v12, v188
  v_exp_f32 v13, v189
  v_cvt_pk_bf16_f32 v125, v10, v11
  v_add_f32 v7, v7, v10
  v_add_f32 v14, v14, v11
  v_exp_f32 v8, v190
  v_exp_f32 v9, v191
  v_cvt_pk_bf16_f32 v126, v12, v13
  v_add_f32 v7, v7, v12
  v_add_f32 v14, v14, v13
  s_nop 0
  v_cvt_pk_bf16_f32 v127, v8, v9
  v_add_f32 v7, v7, v8
  v_add_f32 v14, v14, v9
  s_nop 0
  v_add_f32 v7, v7, v14
  v_cmp_nge_f32 vcc, s25, v7
  s_nop 0
  s_cbranch_vccnz L_afb_33
L_acont_34:
  v_add_f32 v6, v6, v7
  s_add_u32 s21, s21, 2
  s_cmp_lt_u32 s21, 32
  s_cbranch_scc1 L_a_loop
  v_mfma_f32_32x32x16_bf16 v[80:95], v[240:243], v[112:115], v[80:95]
  v_mfma_f32_32x32x16_bf16 v[80:95], v[244:247], v[116:119], v[80:95]
  v_mfma_f32_32x32x16_bf16 v[80:95], v[248:251], v[120:123], v[80:95]
  v_mfma_f32_32x32x16_bf16 v[80:95], v[252:255], v[124:127], v[80:95]
  s_barrier
  s_barrier
  s_nop 15
  v_mov_b32 v15, v5
  v_mov_b32 v0, v5
  s_nop 1
  v_permlane32_swap_b32 v15, v0
  v_add_f32 v15, v15, v0
  v_rcp_f32 v15, v15
  s_nop 0
  v_mul_f32 v64, v15, v64
  v_mul_f32 v65, v15, v65
  v_mul_f32 v66, v15, v66
  v_mul_f32 v67, v15, v67
  v_mul_f32 v68, v15, v68
  v_mul_f32 v69, v15, v69
  v_mul_f32 v70, v15, v70
  v_mul_f32 v71, v15, v71
  v_mul_f32 v72, v15, v72
  v_mul_f32 v73, v15, v73
  v_mul_f32 v74, v15, v74
  v_mul_f32 v75, v15, v75
  v_mul_f32 v76, v15, v76
  v_mul_f32 v77, v15, v77
  v_mul_f32 v78, v15, v78
  v_mul_f32 v79, v15, v79
  v_cvt_pk_bf16_f32 v96, v64, v65
  v_cvt_pk_bf16_f32 v97, v66, v67
  v_cvt_pk_bf16_f32 v98, v68, v69
  v_cvt_pk_bf16_f32 v99, v70, v71
  v_cvt_pk_bf16_f32 v100, v72, v73
  v_cvt_pk_bf16_f32 v101, v74, v75
  v_cvt_pk_bf16_f32 v102, v76, v77
  v_cvt_pk_bf16_f32 v103, v78, v79
  s_nop 1
  v_permlane32_swap_b32 v96, v98
  v_permlane32_swap_b32 v97, v99
  v_permlane32_swap_b32 v100, v102
  v_permlane32_swap_b32 v101, v103
  buffer_store_dwordx4 v[96:99], v4, s[16:19], 0 offen offset:0
  buffer_store_dwordx4 v[100:103], v4, s[16:19], 0 offen offset:32
  v_mov_b32 v15, v6
  v_mov_b32 v0, v6
  s_nop 1
  v_permlane32_swap_b32 v15, v0
  v_add_f32 v15, v15, v0
  v_rcp_f32 v15, v15
  s_nop 0
  v_mul_f32 v80, v15, v80
  v_mul_f32 v81, v15, v81
  v_mul_f32 v82, v15, v82
  v_mul_f32 v83, v15, v83
  v_mul_f32 v84, v15, v84
  v_mul_f32 v85, v15, v85
  v_mul_f32 v86, v15, v86
  v_mul_f32 v87, v15, v87
  v_mul_f32 v88, v15, v88
  v_mul_f32 v89, v15, v89
  v_mul_f32 v90, v15, v90
  v_mul_f32 v91, v15, v91
  v_mul_f32 v92, v15, v92
  v_mul_f32 v93, v15, v93
  v_mul_f32 v94, v15, v94
  v_mul_f32 v95, v15, v95
  v_cvt_pk_bf16_f32 v112, v80, v81
  v_cvt_pk_bf16_f32 v113, v82, v83
  v_cvt_pk_bf16_f32 v114, v84, v85
  v_cvt_pk_bf16_f32 v115, v86, v87
  v_cvt_pk_bf16_f32 v116, v88, v89
  v_cvt_pk_bf16_f32 v117, v90, v91
  v_cvt_pk_bf16_f32 v118, v92, v93
  v_cvt_pk_bf16_f32 v119, v94, v95
  s_nop 1
  v_permlane32_swap_b32 v112, v114
  v_permlane32_swap_b32 v113, v115
  v_permlane32_swap_b32 v116, v118
  v_permlane32_swap_b32 v117, v119
  buffer_store_dwordx4 v[112:115], v4, s[16:19], 0 offen offset:2048
  buffer_store_dwordx4 v[116:119], v4, s[16:19], 0 offen offset:2080
  s_branch L_k2_end
L_a_fb0:
  s_nop 15
  v_max3_f32 v15, v128, v129, v130
  v_max3_f32 v15, v15, v131, v132
  v_max3_f32 v15, v15, v133, v134
  v_max3_f32 v15, v15, v135, v136
  v_max3_f32 v15, v15, v137, v138
  v_max3_f32 v15, v15, v139, v140
  v_max3_f32 v15, v15, v141, v142
  v_max3_f32 v15, v15, v143, v144
  v_max3_f32 v15, v15, v145, v146
  v_max3_f32 v15, v15, v147, v148
  v_max3_f32 v15, v15, v149, v150
  v_max3_f32 v15, v15, v151, v152
  v_max3_f32 v15, v15, v153, v154
  v_max3_f32 v15, v15, v155, v156
  v_max3_f32 v15, v15, v157, v158
  v_max_f32 v15, v15, v159
  v_mov_b32 v0, v15
  s_nop 1
  v_permlane32_swap_b32 v15, v0
  v_max3_f32 v15, v15, v0, s26
  v_max_f32 v0, 0, v15
  v_exp_f32 v0, -v0
  v_sub_f32 v128, v128, v15
  v_sub_f32 v129, v129, v15
  v_sub_f32 v130, v130, v15
  v_sub_f32 v131, v131, v15
  v_sub_f32 v132, v132, v15
  v_sub_f32 v133, v133, v15
  v_sub_f32 v134, v134, v15
  v_sub_f32 v135, v135, v15
  v_sub_f32 v136, v136, v15
  v_sub_f32 v137, v137, v15
  v_sub_f32 v138, v138, v15
  v_sub_f32 v139, v139, v15
  v_sub_f32 v140, v140, v15
  v_sub_f32 v141, v141, v15
  v_sub_f32 v142, v142, v15
  v_sub_f32 v143, v143, v15
  v_sub_f32 v144, v144, v15
  v_sub_f32 v145, v145, v15
  v_sub_f32 v146, v146, v15
  v_sub_f32 v147, v147, v15
  v_sub_f32 v148, v148, v15
  v_sub_f32 v149, v149, v15
  v_sub_f32 v150, v150, v15
  v_sub_f32 v151, v151, v15
  v_sub_f32 v152, v152, v15
  v_sub_f32 v153, v153, v15
  v_sub_f32 v154, v154, v15
  v_sub_f32 v155, v155, v15
  v_sub_f32 v156, v156, v15
  v_sub_f32 v157, v157, v15
  v_sub_f32 v158, v158, v15
  v_sub_f32 v159, v159, v15
  v_sub_f32 v32, v32, v15
  v_mul_f32 v64, v64, v0
  v_sub_f32 v33, v33, v15
  v_mul_f32 v65, v65, v0
  v_sub_f32 v34, v34, v15
  v_mul_f32 v66, v66, v0
  v_sub_f32 v35, v35, v15
  v_mul_f32 v67, v67, v0
  v_sub_f32 v36, v36, v15
  v_mul_f32 v68, v68, v0
  v_sub_f32 v37, v37, v15
  v_mul_f32 v69, v69, v0
  v_sub_f32 v38, v38, v15
  v_mul_f32 v70, v70, v0
  v_sub_f32 v39, v39, v15
  v_mul_f32 v71, v71, v0
  v_sub_f32 v40, v40, v15
  v_mul_f32 v72, v72, v0
  v_sub_f32 v41, v41, v15
  v_mul_f32 v73, v73, v0
  v_sub_f32 v42, v42, v15
  v_mul_f32 v74, v74, v0
  v_sub_f32 v43, v43, v15
  v_mul_f32 v75, v75, v0
  v_sub_f32 v44, v44, v15
  v_mul_f32 v76, v76, v0
  v_sub_f32 v45, v45, v15
  v_mul_f32 v77, v77, v0
  v_sub_f32 v46, v46, v15
  v_mul_f32 v78, v78, v0
  v_sub_f32 v47, v47, v15
  v_mul_f32 v79, v79, v0
  v_mul_f32 v5, v5, v0
  s_mov_b32 s24, 0x5d800000
  s_mov_b32 s26, 0
  v_exp_f32 v8, v128
  v_exp_f32 v9, v129
  v_exp_f32 v10, v130
  v_exp_f32 v11, v131
  v_cvt_pk_bf16_f32 v96, v8, v9
  v_mov_b32 v7, v8
  v_mov_b32 v14, v9
  v_exp_f32 v12, v132
  v_exp_f32 v13, v133
  v_cvt_pk_bf16_f32 v97, v10, v11
  v_add_f32 v7, v7, v10
  v_add_f32 v14, v14, v11
  v_exp_f32 v8, v134
  v_exp_f32 v9, v135
  v_cvt_pk_bf16_f32 v98, v12, v13
  v_add_f32 v7, v7, v12
  v_add_f32 v14, v14, v13
  v_exp_f32 v10, v136
  v_exp_f32 v11, v137
  v_cvt_pk_bf16_f32 v99, v8, v9
  v_add_f32 v7, v7, v8
  v_add_f32 v14, v14, v9
  v_exp_f32 v12, v138
  v_exp_f32 v13, v139
  v_cvt_pk_bf16_f32 v100, v10, v11
  v_add_f32 v7, v7, v10
  v_add_f32 v14, v14, v11
  v_exp_f32 v8, v140
  v_exp_f32 v9, v141
  v_cvt_pk_bf16_f32 v101, v12, v13
  v_add_f32 v7, v7, v12
  v_add_f32 v14, v14, v13
  v_exp_f32 v10, v142
  v_exp_f32 v11, v143
  v_cvt_pk_bf16_f32 v102, v8, v9
  v_add_f32 v7, v7, v8
  v_add_f32 v14, v14, v9
  v_exp_f32 v12, v144
  v_exp_f32 v13, v145
  v_cvt_pk_bf16_f32 v103, v10, v11
  v_add_f32 v7, v7, v10
  v_add_f32 v14, v14, v11
  v_exp_f32 v8, v146
  v_exp_f32 v9, v147
  v_cvt_pk_bf16_f32 v104, v12, v13
  v_add_f32 v7, v7, v12
  v_add_f32 v14, v14, v13
  v_exp_f32 v10, v148
  v_exp_f32 v11, v149
  v_cvt_pk_bf16_f32 v105, v8, v9
  v_add_f32 v7, v7, v8
  v_add_f32 v14, v14, v9
  v_exp_f32 v12, v150
  v_exp_f32 v13, v151
  v_cvt_pk_bf16_f32 v106, v10, v11
  v_add_f32 v7, v7, v10
  v_add_f32 v14, v14, v11
  v_exp_f32 v8, v152
  v_exp_f32 v9, v153
  v_cvt_pk_bf16_f32 v107, v12, v13
  v_add_f32 v7, v7, v12
  v_add_f32 v14, v14, v13
  v_exp_f32 v10, v154
  v_exp_f32 v11, v155
  v_cvt_pk_bf16_f32 v108, v8, v9
  v_add_f32 v7, v7, v8
  v_add_f32 v14, v14, v9
  v_exp_f32 v12, v156
  v_exp_f32 v13, v157
  v_cvt_pk_bf16_f32 v109, v10, v11
  v_add_f32 v7, v7, v10
  v_add_f32 v14, v14, v11
  v_exp_f32 v8, v158
  v_exp_f32 v9, v159
  v_cvt_pk_bf16_f32 v110, v12, v13
  v_add_f32 v7, v7, v12
  v_add_f32 v14, v14, v13
  s_nop 0
  v_cvt_pk_bf16_f32 v111, v8, v9
  v_add_f32 v7, v7, v8
  v_add_f32 v14, v14, v9
  s_nop 0
  v_add_f32 v7, v7, v14
  s_setpc_b64 s[30:31]
L_a_fb1:
  s_nop 15
  v_max3_f32 v15, v160, v161, v162
  v_max3_f32 v15, v15, v163, v164
  v_max3_f32 v15, v15, v165, v166
  v_max3_f32 v15, v15, v167, v168
  v_max3_f32 v15, v15, v169, v170
  v_max3_f32 v15, v15, v171, v172
  v_max3_f32 v15, v15, v173, v174
  v_max3_f32 v15, v15, v175, v176
  v_max3_f32 v15, v15, v177, v178
  v_max3_f32 v15, v15, v179, v180
  v_max3_f32 v15, v15, v181, v182
  v_max3_f32 v15, v15, v183, v184
  v_max3_f32 v15, v15, v185, v186
  v_max3_f32 v15, v15, v187, v188
  v_max3_f32 v15, v15, v189, v190
  v_max_f32 v15, v15, v191
  v_mov_b32 v0, v15
  s_nop 1
  v_permlane32_swap_b32 v15, v0
  v_max3_f32 v15, v15, v0, s27
  v_max_f32 v0, 0, v15
  v_exp_f32 v0, -v0
  v_sub_f32 v160, v160, v15
  v_sub_f32 v161, v161, v15
  v_sub_f32 v162, v162, v15
  v_sub_f32 v163, v163, v15
  v_sub_f32 v164, v164, v15
  v_sub_f32 v165, v165, v15
  v_sub_f32 v166, v166, v15
  v_sub_f32 v167, v167, v15
  v_sub_f32 v168, v168, v15
  v_sub_f32 v169, v169, v15
  v_sub_f32 v170, v170, v15
  v_sub_f32 v171, v171, v15
  v_sub_f32 v172, v172, v15
  v_sub_f32 v173, v173, v15
  v_sub_f32 v174, v174, v15
  v_sub_f32 v175, v175, v15
  v_sub_f32 v176, v176, v15
  v_sub_f32 v177, v177, v15
  v_sub_f32 v178, v178, v15
  v_sub_f32 v179, v179, v15
  v_sub_f32 v180, v180, v15
  v_sub_f32 v181, v181, v15
  v_sub_f32 v182, v182, v15
  v_sub_f32 v183, v183, v15
  v_sub_f32 v184, v184, v15
  v_sub_f32 v185, v185, v15
  v_sub_f32 v186, v186, v15
  v_sub_f32 v187, v187, v15
  v_sub_f32 v188, v188, v15
  v_sub_f32 v189, v189, v15
  v_sub_f32 v190, v190, v15
  v_sub_f32 v191, v191, v15
  v_sub_f32 v48, v48, v15
  v_mul_f32 v80, v80, v0
  v_sub_f32 v49, v49, v15
  v_mul_f32 v81, v81, v0
  v_sub_f32 v50, v50, v15
  v_mul_f32 v82, v82, v0
  v_sub_f32 v51, v51, v15
  v_mul_f32 v83, v83, v0
  v_sub_f32 v52, v52, v15
  v_mul_f32 v84, v84, v0
  v_sub_f32 v53, v53, v15
  v_mul_f32 v85, v85, v0
  v_sub_f32 v54, v54, v15
  v_mul_f32 v86, v86, v0
  v_sub_f32 v55, v55, v15
  v_mul_f32 v87, v87, v0
  v_sub_f32 v56, v56, v15
  v_mul_f32 v88, v88, v0
  v_sub_f32 v57, v57, v15
  v_mul_f32 v89, v89, v0
  v_sub_f32 v58, v58, v15
  v_mul_f32 v90, v90, v0
  v_sub_f32 v59, v59, v15
  v_mul_f32 v91, v91, v0
  v_sub_f32 v60, v60, v15
  v_mul_f32 v92, v92, v0
  v_sub_f32 v61, v61, v15
  v_mul_f32 v93, v93, v0
  v_sub_f32 v62, v62, v15
  v_mul_f32 v94, v94, v0
  v_sub_f32 v63, v63, v15
  v_mul_f32 v95, v95, v0
  v_mul_f32 v6, v6, v0
  s_mov_b32 s25, 0x5d800000
  s_mov_b32 s27, 0
  v_exp_f32 v8, v160
  v_exp_f32 v9, v161
  v_exp_f32 v10, v162
  v_exp_f32 v11, v163
  v_cvt_pk_bf16_f32 v112, v8, v9
  v_mov_b32 v7, v8
  v_mov_b32 v14, v9
  v_exp_f32 v12, v164
  v_exp_f32 v13, v165
  v_cvt_pk_bf16_f32 v113, v10, v11
  v_add_f32 v7, v7, v10
  v_add_f32 v14, v14, v11
  v_exp_f32 v8, v166
  v_exp_f32 v9, v167
  v_cvt_pk_bf16_f32 v114, v12, v13
  v_add_f32 v7, v7, v12
  v_add_f32 v14, v14, v13
  v_exp_f32 v10, v168
  v_exp_f32 v11, v169
  v_cvt_pk_bf16_f32 v115, v8, v9
  v_add_f32 v7, v7, v8
  v_add_f32 v14, v14, v9
  v_exp_f32 v12, v170
  v_exp_f32 v13, v171
  v_cvt_pk_bf16_f32 v116, v10, v11
  v_add_f32 v7, v7, v10
  v_add_f32 v14, v14, v11
  v_exp_f32 v8, v172
  v_exp_f32 v9, v173
  v_cvt_pk_bf16_f32 v117, v12, v13
  v_add_f32 v7, v7, v12
  v_add_f32 v14, v14, v13
  v_exp_f32 v10, v174
  v_exp_f32 v11, v175
  v_cvt_pk_bf16_f32 v118, v8, v9
  v_add_f32 v7, v7, v8
  v_add_f32 v14, v14, v9
  v_exp_f32 v12, v176
  v_exp_f32 v13, v177
  v_cvt_pk_bf16_f32 v119, v10, v11
  v_add_f32 v7, v7, v10
  v_add_f32 v14, v14, v11
  v_exp_f32 v8, v178
  v_exp_f32 v9, v179
  v_cvt_pk_bf16_f32 v120, v12, v13
  v_add_f32 v7, v7, v12
  v_add_f32 v14, v14, v13
  v_exp_f32 v10, v180
  v_exp_f32 v11, v181
  v_cvt_pk_bf16_f32 v121, v8, v9
  v_add_f32 v7, v7, v8
  v_add_f32 v14, v14, v9
  v_exp_f32 v12, v182
  v_exp_f32 v13, v183
  v_cvt_pk_bf16_f32 v122, v10, v11
  v_add_f32 v7, v7, v10
  v_add_f32 v14, v14, v11
  v_exp_f32 v8, v184
  v_exp_f32 v9, v185
  v_cvt_pk_bf16_f32 v123, v12, v13
  v_add_f32 v7, v7, v12
  v_add_f32 v14, v14, v13
  v_exp_f32 v10, v186
  v_exp_f32 v11, v187
  v_cvt_pk_bf16_f32 v124, v8, v9
  v_add_f32 v7, v7, v8
  v_add_f32 v14, v14, v9
  v_exp_f32 v12, v188
  v_exp_f32 v13, v189
  v_cvt_pk_bf16_f32 v125, v10, v11
  v_add_f32 v7, v7, v10
  v_add_f32 v14, v14, v11
  v_exp_f32 v8, v190
  v_exp_f32 v9, v191
  v_cvt_pk_bf16_f32 v126, v12, v13
  v_add_f32 v7, v7, v12
  v_add_f32 v14, v14, v13
  s_nop 0
  v_cvt_pk_bf16_f32 v127, v8, v9
  v_add_f32 v7, v7, v8
  v_add_f32 v14, v14, v9
  s_nop 0
  v_add_f32 v7, v7, v14
  s_setpc_b64 s[30:31]
L_afb_27:
  s_getpc_b64 s[30:31]
L_pc_35:
  s_add_u32 s30, s30, L_acont_28-L_pc_35
  s_addc_u32 s31, s31, -1
  s_branch L_a_fb0
L_afb_29:
  s_getpc_b64 s[30:31]
L_pc_36:
  s_add_u32 s30, s30, L_acont_30-L_pc_36
  s_addc_u32 s31, s31, -1
  s_branch L_a_fb1
L_afb_31:
  s_getpc_b64 s[30:31]
L_pc_37:
  s_add_u32 s30, s30, L_acont_32-L_pc_37
  s_addc_u32 s31, s31, -1
  s_branch L_a_fb0
L_afb_33:
  s_getpc_b64 s[30:31]
L_pc_38:
  s_add_u32 s30, s30, L_acont_34-L_pc_38
  s_addc_u32 s31, s31, -1
  s_branch L_a_fb1
L_k2_end:
  s_endpgm
.globl k3_out_kernel
.p2align 8
.type k3_out_kernel,@function
k3_out_kernel:
  s_load_dwordx16 s[32:47], s[0:1], 0
  s_load_dwordx8 s[48:55], s[0:1], 64
  s_load_dwordx4 s[56:59], s[0:1], 96
  s_cmp_ge_u32 s2, 256
  s_cbranch_scc1 L_k3_end
  s_waitcnt lgkmcnt(0)
  s_and_b32 s76, s2, 7
  s_lshr_b32 s77, s2, 3
  s_and_b32 s61, s76, 1
  s_lshr_b32 s62, s76, 1
  s_lshl_b32 s62, s62, 2
  s_and_b32 s63, s77, 3
  s_add_u32 s62, s62, s63
  s_lshr_b32 s63, s77, 2
  s_lshl_b32 s60, s63, 4
  s_add_u32 s60, s60, s62
  s_mov_b32 s17, 2048
  s_mov_b32 s18, 4096
  s_mov_b32 s64, 1
  s_mul_i32 s77, s61, 2560
  s_mul_i32 s76, s62, 1048576
  s_lshl_b32 s27, s77, 1
  s_add_u32 s76, s76, s27
  s_add_u32 s4, s58, 0x3c00000
  s_addc_u32 s5, s59, 0
  s_add_u32 s4, s4, s76
  s_addc_u32 s5, s5, 0
  s_sub_u32 s6, 0x1000000, s76
  s_mov_b32 s7, 0x00020000
  s_mul_i32 s76, s63, 256
  s_lshl_b32 s27, s77, 11
  s_add_u32 s76, s76, s27
  s_add_u32 s8, s52, 0x0
  s_addc_u32 s9, s53, 0
  s_add_u32 s8, s8, s76
  s_addc_u32 s9, s9, 0
  s_sub_u32 s10, 0x800000, s76
  s_mov_b32 s11, 0x00020000
  s_mul_i32 s76, s62, 524288
  s_mul_i32 s77, s63, 256
  s_add_u32 s76, s76, s77
  s_add_u32 s12, s54, 0x800
  s_addc_u32 s13, s55, 0
  s_add_u32 s12, s12, s76
  s_addc_u32 s13, s13, 0
  s_sub_u32 s14, 0x7ff800, s76
  s_mov_b32 s15, 0x00020000
  s_mov_b32 s16, 8192
  s_cmp_eq_u32 s61, 1
  s_cselect_b32 s19, 24, 40
L_k3_gemm:
  v_and_b32 v1, 63, v0
  v_lshrrev_b32 v17, 6, v0
  s_nop 0
  v_readfirstlane_b32 s21, v17
  s_nop 3
  s_lshl_b32 s26, s21, 10
  s_and_b32 s27, s21, 1
  s_lshl_b32 s28, s27, 2
  v_lshrrev_b32 v17, 4, v1
  v_or_b32 v17, s28, v17
  v_and_b32 v18, 7, v1
  v_xor_b32 v17, v17, v18
  v_lshlrev_b32 v17, 4, v17
  v_lshrrev_b32 v18, 3, v1
  s_lshl_b32 s28, s21, 3
  v_add_u32 v18, s28, v18
  v_add_u32 v19, 0, v18
  v_mul_lo_u32 v19, v19, s16
  v_add_u32 v2, v19, v17
  v_add_u32 v19, 64, v18
  v_mul_lo_u32 v19, v19, s16
  v_add_u32 v3, v19, v17
  v_lshrrev_b32 v17, 4, v1
  v_lshlrev_b32 v18, 2, v17
  v_and_b32 v19, 15, v1
  v_xor_b32 v18, v18, v19
  v_lshlrev_b32 v18, 4, v18
  s_lshl_b32 s28, s21, 2
  v_add_u32 v17, s28, v17
  v_add_u32 v19, 0, v17
  v_mul_lo_u32 v19, v19, s17
  v_add_u32 v6, v19, v18
  v_add_u32 v19, 32, v17
  v_mul_lo_u32 v19, v19, s17
  v_add_u32 v7, v19, v18
  s_and_b32 s27, s21, 1
  s_lshr_b32 s28, s21, 1
  s_and_b32 s28, s28, 1
  v_and_b32 v17, 31, v1
  s_mul_i32 s22, s27, 64
  v_add_u32 v17, s22, v17
  v_mul_lo_u32 v16, v17, s18
  v_lshlrev_b32 v17, 7, v17
  v_lshrrev_b32 v18, 5, v1
  v_bfe_u32 v19, v1, 1, 3
  v_xor_b32 v19, v19, v18
  v_xor_b32 v20, 0, v19
  v_lshl_add_u32 v10, v20, 4, v17
  v_xor_b32 v20, 2, v19
  v_lshl_add_u32 v11, v20, 4, v17
  v_xor_b32 v20, 4, v19
  v_lshl_add_u32 v12, v20, 4, v17
  v_xor_b32 v20, 6, v19
  v_lshl_add_u32 v13, v20, 4, v17
  s_mul_i32 s22, s28, 128
  v_lshl_add_u32 v16, v18, 4, v16
  v_add_u32 v16, s22, v16
  v_bfe_u32 v17, v1, 2, 2
  v_lshl_add_u32 v18, v18, 3, v17
  v_mul_u32_u24 v18, 256, v18
  v_and_b32 v19, 1, v1
  v_lshl_add_u32 v18, v19, 3, v18
  v_add_u32 v18, 0x10000, v18
  v_bfe_u32 v19, v1, 4, 1
  v_bfe_u32 v20, v1, 1, 1
  v_lshl_add_u32 v19, v19, 1, v20
  s_mul_i32 s22, s28, 8
  v_add_u32 v19, s22, v19
  v_lshlrev_b32 v17, 2, v17
  v_add_u32 v20, 0, v19
  v_xor_b32 v20, v20, v17
  v_lshl_add_u32 v14, v20, 4, v18
  v_add_u32 v20, 4, v19
  v_xor_b32 v20, v20, v17
  v_lshl_add_u32 v15, v20, 4, v18
  s_lshl_b32 s24, s17, 6
  s_mov_b32 s22, 0
  s_mov_b32 s23, 0
  v_add_u32 v88, 0x10000, v10
  v_add_u32 v89, 0x10000, v11
  v_add_u32 v90, 0x10000, v12
  v_add_u32 v91, 0x10000, v13
  v_add_u32 v92, 0x10000, v14
  v_add_u32 v93, 0x10000, v15
  s_add_u32 m0, s26, 0x0
  s_nop 0
  buffer_load_dwordx4 v2, s[4:7], s22 offen lds
  s_add_u32 m0, s26, 0x2000
  s_nop 0
  buffer_load_dwordx4 v3, s[4:7], s22 offen lds
  s_add_u32 m0, s26, 0x10000
  s_nop 0
  buffer_load_dwordx4 v6, s[8:11], s23 offen lds
  s_add_u32 m0, s26, 0x12000
  s_nop 0
  buffer_load_dwordx4 v7, s[8:11], s23 offen lds
  s_add_u32 s22, s22, 128
  s_add_u32 s23, s23, s24
  s_add_u32 m0, s26, 0x4000
  s_nop 0
  buffer_load_dwordx4 v2, s[4:7], s22 offen lds
  s_add_u32 m0, s26, 0x6000
  s_nop 0
  buffer_load_dwordx4 v3, s[4:7], s22 offen lds
  s_add_u32 m0, s26, 0x14000
  s_nop 0
  buffer_load_dwordx4 v6, s[8:11], s23 offen lds
  s_add_u32 m0, s26, 0x16000
  s_nop 0
  buffer_load_dwordx4 v7, s[8:11], s23 offen lds
  s_add_u32 s22, s22, 128
  s_add_u32 s23, s23, s24
  s_add_u32 m0, s26, 0x8000
  s_nop 0
  buffer_load_dwordx4 v2, s[4:7], s22 offen lds
  s_add_u32 m0, s26, 0xa000
  s_nop 0
  buffer_load_dwordx4 v3, s[4:7], s22 offen lds
  s_add_u32 m0, s26, 0x18000
  s_nop 0
  buffer_load_dwordx4 v6, s[8:11], s23 offen lds
  s_add_u32 m0, s26, 0x1a000
  s_nop 0
  buffer_load_dwordx4 v7, s[8:11], s23 offen lds
  s_add_u32 s22, s22, 128
  s_add_u32 s23, s23, s24
  v_mov_b32 v128, 0
  v_mov_b32 v129, 0
  v_mov_b32 v130, 0
  v_mov_b32 v131, 0
  v_mov_b32 v132, 0
  v_mov_b32 v133, 0
  v_mov_b32 v134, 0
  v_mov_b32 v135, 0
  v_mov_b32 v136, 0
  v_mov_b32 v137, 0
  v_mov_b32 v138, 0
  v_mov_b32 v139, 0
  v_mov_b32 v140, 0
  v_mov_b32 v141, 0
  v_mov_b32 v142, 0
  v_mov_b32 v143, 0
  v_mov_b32 v144, 0
  v_mov_b32 v145, 0
  v_mov_b32 v146, 0
  v_mov_b32 v147, 0
  v_mov_b32 v148, 0
  v_mov_b32 v149, 0
  v_mov_b32 v150, 0
  v_mov_b32 v151, 0
  v_mov_b32 v152, 0
  v_mov_b32 v153, 0
  v_mov_b32 v154, 0
  v_mov_b32 v155, 0
  v_mov_b32 v156, 0
  v_mov_b32 v157, 0
  v_mov_b32 v158, 0
  v_mov_b32 v159, 0
  v_mov_b32 v160, 0
  v_mov_b32 v161, 0
  v_mov_b32 v162, 0
  v_mov_b32 v163, 0
  v_mov_b32 v164, 0
  v_mov_b32 v165, 0
  v_mov_b32 v166, 0
  v_mov_b32 v167, 0
  v_mov_b32 v168, 0
  v_mov_b32 v169, 0
  v_mov_b32 v170, 0
  v_mov_b32 v171, 0
  v_mov_b32 v172, 0
  v_mov_b32 v173, 0
  v_mov_b32 v174, 0
  v_mov_b32 v175, 0
  v_mov_b32 v176, 0
  v_mov_b32 v177, 0
  v_mov_b32 v178, 0
  v_mov_b32 v179, 0
  v_mov_b32 v180, 0
  v_mov_b32 v181, 0
  v_mov_b32 v182, 0
  v_mov_b32 v183, 0
  v_mov_b32 v184, 0
  v_mov_b32 v185, 0
  v_mov_b32 v186, 0
  v_mov_b32 v187, 0
  v_mov_b32 v188, 0
  v_mov_b32 v189, 0
  v_mov_b32 v190, 0
  v_mov_b32 v191, 0
  s_mov_b32 s25, 0
  s_waitcnt vmcnt(8)
  s_barrier
  s_cmp_ge_u32 s21, 4
  s_cbranch_scc1 L_k3_g1
L_k3_g0loop:
  s_add_u32 s27, s25, 3
  s_cmp_lt_u32 s27, s19
  s_cbranch_scc0 L_n_39
  ds_read_b64_tr_b16 v[56:57], v14 offset:0
  ds_read_b64_tr_b16 v[58:59], v14 offset:1024
  ds_read_b64_tr_b16 v[60:61], v15 offset:0
  ds_read_b64_tr_b16 v[62:63], v15 offset:1024
  ds_read_b128 v[24:27], v10 offset:0
  ds_read_b128 v[28:31], v10 offset:4096
  ds_read_b64_tr_b16 v[64:65], v14 offset:4096
  ds_read_b64_tr_b16 v[66:67], v14 offset:5120
  ds_read_b64_tr_b16 v[68:69], v15 offset:4096
  ds_read_b64_tr_b16 v[70:71], v15 offset:5120
  ds_read_b128 v[32:35], v11 offset:0
  ds_read_b128 v[36:39], v11 offset:4096
  ds_read_b64_tr_b16 v[72:73], v14 offset:8192
  ds_read_b64_tr_b16 v[74:75], v14 offset:9216
  ds_read_b64_tr_b16 v[76:77], v15 offset:8192
  ds_read_b64_tr_b16 v[78:79], v15 offset:9216
  ds_read_b128 v[40:43], v12 offset:0
  ds_read_b128 v[44:47], v12 offset:4096
  ds_read_b64_tr_b16 v[80:81], v14 offset:12288
  ds_read_b64_tr_b16 v[82:83], v14 offset:13312
  ds_read_b64_tr_b16 v[84:85], v15 offset:12288
  ds_read_b64_tr_b16 v[86:87], v15 offset:13312
  ds_read_b128 v[48:51], v13 offset:0
  ds_read_b128 v[52:55], v13 offset:4096
  s_add_u32 m0, s26, 0xc000
  s_nop 0
  buffer_load_dwordx4 v2, s[4:7], s22 offen lds
  s_add_u32 m0, s26, 0xe000
  s_nop 0
  buffer_load_dwordx4 v3, s[4:7], s22 offen lds
  s_add_u32 m0, s26, 0x1c000
  s_nop 0
  buffer_load_dwordx4 v6, s[8:11], s23 offen lds
  s_add_u32 m0, s26, 0x1e000
  s_nop 0
  buffer_load_dwordx4 v7, s[8:11], s23 offen lds
  s_add_u32 s22, s22, 128
  s_add_u32 s23, s23, s24
  s_waitcnt vmcnt(8) lgkmcnt(0)
  s_branch L_d_40
L_n_39:
  ds_read_b64_tr_b16 v[56:57], v14 offset:0
  ds_read_b64_tr_b16 v[58:59], v14 offset:1024
  ds_read_b64_tr_b16 v[60:61], v15 offset:0
  ds_read_b64_tr_b16 v[62:63], v15 offset:1024
  ds_read_b128 v[24:27], v10 offset:0
  ds_read_b128 v[28:31], v10 offset:4096
  ds_read_b64_tr_b16 v[64:65], v14 offset:4096
  ds_read_b64_tr_b16 v[66:67], v14 offset:5120
  ds_read_b64_tr_b16 v[68:69], v15 offset:4096
  ds_read_b64_tr_b16 v[70:71], v15 offset:5120
  ds_read_b128 v[32:35], v11 offset:0
  ds_read_b128 v[36:39], v11 offset:4096
  ds_read_b64_tr_b16 v[72:73], v14 offset:8192
  ds_read_b64_tr_b16 v[74:75], v14 offset:9216
  ds_read_b64_tr_b16 v[76:77], v15 offset:8192
  ds_read_b64_tr_b16 v[78:79], v15 offset:9216
  ds_read_b128 v[40:43], v12 offset:0
  ds_read_b128 v[44:47], v12 offset:4096
  ds_read_b64_tr_b16 v[80:81], v14 offset:12288
  ds_read_b64_tr_b16 v[82:83], v14 offset:13312
  ds_read_b64_tr_b16 v[84:85], v15 offset:12288
  ds_read_b64_tr_b16 v[86:87], v15 offset:13312
  ds_read_b128 v[48:51], v13 offset:0
  ds_read_b128 v[52:55], v13 offset:4096
  s_waitcnt vmcnt(0) lgkmcnt(0)
L_d_40:
  s_barrier
  s_add_u32 s25, s25, 1
  s_add_u32 s27, s25, 3
  s_cmp_lt_u32 s27, s19
  s_cbranch_scc0 L_n_41
  v_mfma_f32_32x32x16_bf16 v[128:143], v[56:59], v[24:27], v[128:143]
  v_mfma_f32_32x32x16_bf16 v[160:175], v[60:63], v[24:27], v[160:175]
  s_add_u32 m0, s26, 0x0
  s_nop 0
  buffer_load_dwordx4 v2, s[4:7], s22 offen lds
  v_mfma_f32_32x32x16_bf16 v[144:159], v[56:59], v[28:31], v[144:159]
  v_mfma_f32_32x32x16_bf16 v[176:191], v[60:63], v[28:31], v[176:191]
  v_mfma_f32_32x32x16_bf16 v[128:143], v[64:67], v[32:35], v[128:143]
  v_mfma_f32_32x32x16_bf16 v[160:175], v[68:71], v[32:35], v[160:175]
  s_add_u32 m0, s26, 0x2000
  s_nop 0
  buffer_load_dwordx4 v3, s[4:7], s22 offen lds
  v_mfma_f32_32x32x16_bf16 v[144:159], v[64:67], v[36:39], v[144:159]
  v_mfma_f32_32x32x16_bf16 v[176:191], v[68:71], v[36:39], v[176:191]
  v_mfma_f32_32x32x16_bf16 v[128:143], v[72:75], v[40:43], v[128:143]
  v_mfma_f32_32x32x16_bf16 v[160:175], v[76:79], v[40:43], v[160:175]
  s_add_u32 m0, s26, 0x10000
  s_nop 0
  buffer_load_dwordx4 v6, s[8:11], s23 offen lds
  v_mfma_f32_32x32x16_bf16 v[144:159], v[72:75], v[44:47], v[144:159]
  v_mfma_f32_32x32x16_bf16 v[176:191], v[76:79], v[44:47], v[176:191]
  v_mfma_f32_32x32x16_bf16 v[128:143], v[80:83], v[48:51], v[128:143]
  v_mfma_f32_32x32x16_bf16 v[160:175], v[84:87], v[48:51], v[160:175]
  s_add_u32 m0, s26, 0x12000
  s_nop 0
  buffer_load_dwordx4 v7, s[8:11], s23 offen lds
  s_add_u32 s22, s22, 128
  s_add_u32 s23, s23, s24
  v_mfma_f32_32x32x16_bf16 v[144:159], v[80:83], v[52:55], v[144:159]
  v_mfma_f32_32x32x16_bf16 v[176:191], v[84:87], v[52:55], v[176:191]
  s_waitcnt vmcnt(8)
  s_branch L_d_42
L_n_41:
  v_mfma_f32_32x32x16_bf16 v[128:143], v[56:59], v[24:27], v[128:143]
  v_mfma_f32_32x32x16_bf16 v[160:175], v[60:63], v[24:27], v[160:175]
  v_mfma_f32_32x32x16_bf16 v[144:159], v[56:59], v[28:31], v[144:159]
  v_mfma_f32_32x32x16_bf16 v[176:191], v[60:63], v[28:31], v[176:191]
  v_mfma_f32_32x32x16_bf16 v[128:143], v[64:67], v[32:35], v[128:143]
  v_mfma_f32_32x32x16_bf16 v[160:175], v[68:71], v[32:35], v[160:175]
  v_mfma_f32_32x32x16_bf16 v[144:159], v[64:67], v[36:39], v[144:159]
  v_mfma_f32_32x32x16_bf16 v[176:191], v[68:71], v[36:39], v[176:191]
  v_mfma_f32_32x32x16_bf16 v[128:143], v[72:75], v[40:43], v[128:143]
  v_mfma_f32_32x32x16_bf16 v[160:175], v[76:79], v[40:43], v[160:175]
  v_mfma_f32_32x32x16_bf16 v[144:159], v[72:75], v[44:47], v[144:159]
  v_mfma_f32_32x32x16_bf16 v[176:191], v[76:79], v[44:47], v[176:191]
  v_mfma_f32_32x32x16_bf16 v[128:143], v[80:83], v[48:51], v[128:143]
  v_mfma_f32_32x32x16_bf16 v[160:175], v[84:87], v[48:51], v[160:175]
  v_mfma_f32_32x32x16_bf16 v[144:159], v[80:83], v[52:55], v[144:159]
  v_mfma_f32_32x32x16_bf16 v[176:191], v[84:87], v[52:55], v[176:191]
  s_waitcnt vmcnt(0)
L_d_42:
  s_barrier
  s_add_u32 s25, s25, 1
  s_cmp_ge_u32 s25, s19
  s_cbranch_scc1 L_k3_g0end
  s_add_u32 s27, s25, 3
  s_cmp_lt_u32 s27, s19
  s_cbranch_scc0 L_n_43
  ds_read_b64_tr_b16 v[56:57], v14 offset:32768
  ds_read_b64_tr_b16 v[58:59], v14 offset:33792
  ds_read_b64_tr_b16 v[60:61], v15 offset:32768
  ds_read_b64_tr_b16 v[62:63], v15 offset:33792
  ds_read_b128 v[24:27], v10 offset:32768
  ds_read_b128 v[28:31], v10 offset:36864
  ds_read_b64_tr_b16 v[64:65], v14 offset:36864
  ds_read_b64_tr_b16 v[66:67], v14 offset:37888
  ds_read_b64_tr_b16 v[68:69], v15 offset:36864
  ds_read_b64_tr_b16 v[70:71], v15 offset:37888
  ds_read_b128 v[32:35], v11 offset:32768
  ds_read_b128 v[36:39], v11 offset:36864
  ds_read_b64_tr_b16 v[72:73], v14 offset:40960
  ds_read_b64_tr_b16 v[74:75], v14 offset:41984
  ds_read_b64_tr_b16 v[76:77], v15 offset:40960
  ds_read_b64_tr_b16 v[78:79], v15 offset:41984
  ds_read_b128 v[40:43], v12 offset:32768
  ds_read_b128 v[44:47], v12 offset:36864
  ds_read_b64_tr_b16 v[80:81], v14 offset:45056
  ds_read_b64_tr_b16 v[82:83], v14 offset:46080
  ds_read_b64_tr_b16 v[84:85], v15 offset:45056
  ds_read_b64_tr_b16 v[86:87], v15 offset:46080
  ds_read_b128 v[48:51], v13 offset:32768
  ds_read_b128 v[52:55], v13 offset:36864
  s_add_u32 m0, s26, 0x4000
  s_nop 0
  buffer_load_dwordx4 v2, s[4:7], s22 offen lds
  s_add_u32 m0, s26, 0x6000
  s_nop 0
  buffer_load_dwordx4 v3, s[4:7], s22 offen lds
  s_add_u32 m0, s26, 0x14000
  s_nop 0
  buffer_load_dwordx4 v6, s[8:11], s23 offen lds
  s_add_u32 m0, s26, 0x16000
  s_nop 0
  buffer_load_dwordx4 v7, s[8:11], s23 offen lds
  s_add_u32 s22, s22, 128
  s_add_u32 s23, s23, s24
  s_waitcnt vmcnt(8) lgkmcnt(0)
  s_branch L_d_44
L_n_43:
  ds_read_b64_tr_b16 v[56:57], v14 offset:32768
  ds_read_b64_tr_b16 v[58:59], v14 offset:33792
  ds_read_b64_tr_b16 v[60:61], v15 offset:32768
  ds_read_b64_tr_b16 v[62:63], v15 offset:33792
  ds_read_b128 v[24:27], v10 offset:32768
  ds_read_b128 v[28:31], v10 offset:36864
  ds_read_b64_tr_b16 v[64:65], v14 offset:36864
  ds_read_b64_tr_b16 v[66:67], v14 offset:37888
  ds_read_b64_tr_b16 v[68:69], v15 offset:36864
  ds_read_b64_tr_b16 v[70:71], v15 offset:37888
  ds_read_b128 v[32:35], v11 offset:32768
  ds_read_b128 v[36:39], v11 offset:36864
  ds_read_b64_tr_b16 v[72:73], v14 offset:40960
  ds_read_b64_tr_b16 v[74:75], v14 offset:41984
  ds_read_b64_tr_b16 v[76:77], v15 offset:40960
  ds_read_b64_tr_b16 v[78:79], v15 offset:41984
  ds_read_b128 v[40:43], v12 offset:32768
  ds_read_b128 v[44:47], v12 offset:36864
  ds_read_b64_tr_b16 v[80:81], v14 offset:45056
  ds_read_b64_tr_b16 v[82:83], v14 offset:46080
  ds_read_b64_tr_b16 v[84:85], v15 offset:45056
  ds_read_b64_tr_b16 v[86:87], v15 offset:46080
  ds_read_b128 v[48:51], v13 offset:32768
  ds_read_b128 v[52:55], v13 offset:36864
  s_waitcnt vmcnt(0) lgkmcnt(0)
L_d_44:
  s_barrier
  s_add_u32 s25, s25, 1
  s_add_u32 s27, s25, 3
  s_cmp_lt_u32 s27, s19
  s_cbranch_scc0 L_n_45
  v_mfma_f32_32x32x16_bf16 v[128:143], v[56:59], v[24:27], v[128:143]
  v_mfma_f32_32x32x16_bf16 v[160:175], v[60:63], v[24:27], v[160:175]
  s_add_u32 m0, s26, 0x8000
  s_nop 0
  buffer_load_dwordx4 v2, s[4:7], s22 offen lds
  v_mfma_f32_32x32x16_bf16 v[144:159], v[56:59], v[28:31], v[144:159]
  v_mfma_f32_32x32x16_bf16 v[176:191], v[60:63], v[28:31], v[176:191]
  v_mfma_f32_32x32x16_bf16 v[128:143], v[64:67], v[32:35], v[128:143]
  v_mfma_f32_32x32x16_bf16 v[160:175], v[68:71], v[32:35], v[160:175]
  s_add_u32 m0, s26, 0xa000
  s_nop 0
  buffer_load_dwordx4 v3, s[4:7], s22 offen lds
  v_mfma_f32_32x32x16_bf16 v[144:159], v[64:67], v[36:39], v[144:159]
  v_mfma_f32_32x32x16_bf16 v[176:191], v[68:71], v[36:39], v[176:191]
  v_mfma_f32_32x32x16_bf16 v[128:143], v[72:75], v[40:43], v[128:143]
  v_mfma_f32_32x32x16_bf16 v[160:175], v[76:79], v[40:43], v[160:175]
  s_add_u32 m0, s26, 0x18000
  s_nop 0
  buffer_load_dwordx4 v6, s[8:11], s23 offen lds
  v_mfma_f32_32x32x16_bf16 v[144:159], v[72:75], v[44:47], v[144:159]
  v_mfma_f32_32x32x16_bf16 v[176:191], v[76:79], v[44:47], v[176:191]
  v_mfma_f32_32x32x16_bf16 v[128:143], v[80:83], v[48:51], v[128:143]
  v_mfma_f32_32x32x16_bf16 v[160:175], v[84:87], v[48:51], v[160:175]
  s_add_u32 m0, s26, 0x1a000
  s_nop 0
  buffer_load_dwordx4 v7, s[8:11], s23 offen lds
  s_add_u32 s22, s22, 128
  s_add_u32 s23, s23, s24
  v_mfma_f32_32x32x16_bf16 v[144:159], v[80:83], v[52:55], v[144:159]
  v_mfma_f32_32x32x16_bf16 v[176:191], v[84:87], v[52:55], v[176:191]
  s_waitcnt vmcnt(8)
  s_branch L_d_46
L_n_45:
  v_mfma_f32_32x32x16_bf16 v[128:143], v[56:59], v[24:27], v[128:143]
  v_mfma_f32_32x32x16_bf16 v[160:175], v[60:63], v[24:27], v[160:175]
  v_mfma_f32_32x32x16_bf16 v[144:159], v[56:59], v[28:31], v[144:159]
  v_mfma_f32_32x32x16_bf16 v[176:191], v[60:63], v[28:31], v[176:191]
  v_mfma_f32_32x32x16_bf16 v[128:143], v[64:67], v[32:35], v[128:143]
  v_mfma_f32_32x32x16_bf16 v[160:175], v[68:71], v[32:35], v[160:175]
  v_mfma_f32_32x32x16_bf16 v[144:159], v[64:67], v[36:39], v[144:159]
  v_mfma_f32_32x32x16_bf16 v[176:191], v[68:71], v[36:39], v[176:191]
  v_mfma_f32_32x32x16_bf16 v[128:143], v[72:75], v[40:43], v[128:143]
  v_mfma_f32_32x32x16_bf16 v[160:175], v[76:79], v[40:43], v[160:175]
  v_mfma_f32_32x32x16_bf16 v[144:159], v[72:75], v[44:47], v[144:159]
  v_mfma_f32_32x32x16_bf16 v[176:191], v[76:79], v[44:47], v[176:191]
  v_mfma_f32_32x32x16_bf16 v[128:143], v[80:83], v[48:51], v[128:143]
  v_mfma_f32_32x32x16_bf16 v[160:175], v[84:87], v[48:51], v[160:175]
  v_mfma_f32_32x32x16_bf16 v[144:159], v[80:83], v[52:55], v[144:159]
  v_mfma_f32_32x32x16_bf16 v[176:191], v[84:87], v[52:55], v[176:191]
  s_waitcnt vmcnt(0)
L_d_46:
  s_barrier
  s_add_u32 s25, s25, 1
  s_cmp_ge_u32 s25, s19
  s_cbranch_scc1 L_k3_g0end
  s_branch L_k3_g0loop
L_k3_g0end:
  s_barrier
  s_branch L_k3_epi
L_k3_g1:
  s_add_u32 m0, s26, 0xc000
  s_nop 0
  buffer_load_dwordx4 v2, s[4:7], s22 offen lds
  s_add_u32 m0, s26, 0xe000
  s_nop 0
  buffer_load_dwordx4 v3, s[4:7], s22 offen lds
  s_add_u32 m0, s26, 0x1c000
  s_nop 0
  buffer_load_dwordx4 v6, s[8:11], s23 offen lds
  s_add_u32 m0, s26, 0x1e000
  s_nop 0
  buffer_load_dwordx4 v7, s[8:11], s23 offen lds
  s_add_u32 s22, s22, 128
  s_add_u32 s23, s23, s24
  s_waitcnt vmcnt(8)
  s_barrier
  s_add_u32 s25, s25, 1
L_k3_g1loop:
  s_add_u32 s27, s25, 3
  s_cmp_lt_u32 s27, s19
  s_cbranch_scc0 L_n_47
  ds_read_b64_tr_b16 v[56:57], v14 offset:16384
  ds_read_b64_tr_b16 v[58:59], v14 offset:17408
  ds_read_b64_tr_b16 v[60:61], v15 offset:16384
  ds_read_b64_tr_b16 v[62:63], v15 offset:17408
  ds_read_b128 v[24:27], v10 offset:16384
  ds_read_b128 v[28:31], v10 offset:20480
  ds_read_b64_tr_b16 v[64:65], v14 offset:20480
  ds_read_b64_tr_b16 v[66:67], v14 offset:21504
  ds_read_b64_tr_b16 v[68:69], v15 offset:20480
  ds_read_b64_tr_b16 v[70:71], v15 offset:21504
  ds_read_b128 v[32:35], v11 offset:16384
  ds_read_b128 v[36:39], v11 offset:20480
  ds_read_b64_tr_b16 v[72:73], v14 offset:24576
  ds_read_b64_tr_b16 v[74:75], v14 offset:25600
  ds_read_b64_tr_b16 v[76:77], v15 offset:24576
  ds_read_b64_tr_b16 v[78:79], v15 offset:25600
  ds_read_b128 v[40:43], v12 offset:16384
  ds_read_b128 v[44:47], v12 offset:20480
  ds_read_b64_tr_b16 v[80:81], v14 offset:28672
  ds_read_b64_tr_b16 v[82:83], v14 offset:29696
  ds_read_b64_tr_b16 v[84:85], v15 offset:28672
  ds_read_b64_tr_b16 v[86:87], v15 offset:29696
  ds_read_b128 v[48:51], v13 offset:16384
  ds_read_b128 v[52:55], v13 offset:20480
  s_add_u32 m0, s26, 0x0
  s_nop 0
  buffer_load_dwordx4 v2, s[4:7], s22 offen lds
  s_add_u32 m0, s26, 0x2000
  s_nop 0
  buffer_load_dwordx4 v3, s[4:7], s22 offen lds
  s_add_u32 m0, s26, 0x10000
  s_nop 0
  buffer_load_dwordx4 v6, s[8:11], s23 offen lds
  s_add_u32 m0, s26, 0x12000
  s_nop 0
  buffer_load_dwordx4 v7, s[8:11], s23 offen lds
  s_add_u32 s22, s22, 128
  s_add_u32 s23, s23, s24
  s_waitcnt vmcnt(8) lgkmcnt(0)
  s_branch L_d_48
L_n_47:
  ds_read_b64_tr_b16 v[56:57], v14 offset:16384
  ds_read_b64_tr_b16 v[58:59], v14 offset:17408
  ds_read_b64_tr_b16 v[60:61], v15 offset:16384
  ds_read_b64_tr_b16 v[62:63], v15 offset:17408
  ds_read_b128 v[24:27], v10 offset:16384
  ds_read_b128 v[28:31], v10 offset:20480
  ds_read_b64_tr_b16 v[64:65], v14 offset:20480
  ds_read_b64_tr_b16 v[66:67], v14 offset:21504
  ds_read_b64_tr_b16 v[68:69], v15 offset:20480
  ds_read_b64_tr_b16 v[70:71], v15 offset:21504
  ds_read_b128 v[32:35], v11 offset:16384
  ds_read_b128 v[36:39], v11 offset:20480
  ds_read_b64_tr_b16 v[72:73], v14 offset:24576
  ds_read_b64_tr_b16 v[74:75], v14 offset:25600
  ds_read_b64_tr_b16 v[76:77], v15 offset:24576
  ds_read_b64_tr_b16 v[78:79], v15 offset:25600
  ds_read_b128 v[40:43], v12 offset:16384
  ds_read_b128 v[44:47], v12 offset:20480
  ds_read_b64_tr_b16 v[80:81], v14 offset:28672
  ds_read_b64_tr_b16 v[82:83], v14 offset:29696
  ds_read_b64_tr_b16 v[84:85], v15 offset:28672
  ds_read_b64_tr_b16 v[86:87], v15 offset:29696
  ds_read_b128 v[48:51], v13 offset:16384
  ds_read_b128 v[52:55], v13 offset:20480
  s_waitcnt vmcnt(0) lgkmcnt(0)
L_d_48:
  s_barrier
  s_add_u32 s25, s25, 1
  s_add_u32 s27, s25, 3
  s_cmp_lt_u32 s27, s19
  s_cbranch_scc0 L_n_49
  v_mfma_f32_32x32x16_bf16 v[128:143], v[56:59], v[24:27], v[128:143]
  v_mfma_f32_32x32x16_bf16 v[160:175], v[60:63], v[24:27], v[160:175]
  s_add_u32 m0, s26, 0x4000
  s_nop 0
  buffer_load_dwordx4 v2, s[4:7], s22 offen lds
  v_mfma_f32_32x32x16_bf16 v[144:159], v[56:59], v[28:31], v[144:159]
  v_mfma_f32_32x32x16_bf16 v[176:191], v[60:63], v[28:31], v[176:191]
  v_mfma_f32_32x32x16_bf16 v[128:143], v[64:67], v[32:35], v[128:143]
  v_mfma_f32_32x32x16_bf16 v[160:175], v[68:71], v[32:35], v[160:175]
  s_add_u32 m0, s26, 0x6000
  s_nop 0
  buffer_load_dwordx4 v3, s[4:7], s22 offen lds
  v_mfma_f32_32x32x16_bf16 v[144:159], v[64:67], v[36:39], v[144:159]
  v_mfma_f32_32x32x16_bf16 v[176:191], v[68:71], v[36:39], v[176:191]
  v_mfma_f32_32x32x16_bf16 v[128:143], v[72:75], v[40:43], v[128:143]
  v_mfma_f32_32x32x16_bf16 v[160:175], v[76:79], v[40:43], v[160:175]
  s_add_u32 m0, s26, 0x14000
  s_nop 0
  buffer_load_dwordx4 v6, s[8:11], s23 offen lds
  v_mfma_f32_32x32x16_bf16 v[144:159], v[72:75], v[44:47], v[144:159]
  v_mfma_f32_32x32x16_bf16 v[176:191], v[76:79], v[44:47], v[176:191]
  v_mfma_f32_32x32x16_bf16 v[128:143], v[80:83], v[48:51], v[128:143]
  v_mfma_f32_32x32x16_bf16 v[160:175], v[84:87], v[48:51], v[160:175]
  s_add_u32 m0, s26, 0x16000
  s_nop 0
  buffer_load_dwordx4 v7, s[8:11], s23 offen lds
  s_add_u32 s22, s22, 128
  s_add_u32 s23, s23, s24
  v_mfma_f32_32x32x16_bf16 v[144:159], v[80:83], v[52:55], v[144:159]
  v_mfma_f32_32x32x16_bf16 v[176:191], v[84:87], v[52:55], v[176:191]
  s_waitcnt vmcnt(8)
  s_branch L_d_50
L_n_49:
  v_mfma_f32_32x32x16_bf16 v[128:143], v[56:59], v[24:27], v[128:143]
  v_mfma_f32_32x32x16_bf16 v[160:175], v[60:63], v[24:27], v[160:175]
  v_mfma_f32_32x32x16_bf16 v[144:159], v[56:59], v[28:31], v[144:159]
  v_mfma_f32_32x32x16_bf16 v[176:191], v[60:63], v[28:31], v[176:191]
  v_mfma_f32_32x32x16_bf16 v[128:143], v[64:67], v[32:35], v[128:143]
  v_mfma_f32_32x32x16_bf16 v[160:175], v[68:71], v[32:35], v[160:175]
  v_mfma_f32_32x32x16_bf16 v[144:159], v[64:67], v[36:39], v[144:159]
  v_mfma_f32_32x32x16_bf16 v[176:191], v[68:71], v[36:39], v[176:191]
  v_mfma_f32_32x32x16_bf16 v[128:143], v[72:75], v[40:43], v[128:143]
  v_mfma_f32_32x32x16_bf16 v[160:175], v[76:79], v[40:43], v[160:175]
  v_mfma_f32_32x32x16_bf16 v[144:159], v[72:75], v[44:47], v[144:159]
  v_mfma_f32_32x32x16_bf16 v[176:191], v[76:79], v[44:47], v[176:191]
  v_mfma_f32_32x32x16_bf16 v[128:143], v[80:83], v[48:51], v[128:143]
  v_mfma_f32_32x32x16_bf16 v[160:175], v[84:87], v[48:51], v[160:175]
  v_mfma_f32_32x32x16_bf16 v[144:159], v[80:83], v[52:55], v[144:159]
  v_mfma_f32_32x32x16_bf16 v[176:191], v[84:87], v[52:55], v[176:191]
  s_waitcnt vmcnt(0)
L_d_50:
  s_barrier
  s_add_u32 s25, s25, 1
  s_cmp_gt_u32 s25, s19
  s_cbranch_scc1 L_k3_epi
  s_add_u32 s27, s25, 3
  s_cmp_lt_u32 s27, s19
  s_cbranch_scc0 L_n_51
  ds_read_b64_tr_b16 v[56:57], v14 offset:49152
  ds_read_b64_tr_b16 v[58:59], v14 offset:50176
  ds_read_b64_tr_b16 v[60:61], v15 offset:49152
  ds_read_b64_tr_b16 v[62:63], v15 offset:50176
  ds_read_b128 v[24:27], v10 offset:49152
  ds_read_b128 v[28:31], v10 offset:53248
  ds_read_b64_tr_b16 v[64:65], v14 offset:53248
  ds_read_b64_tr_b16 v[66:67], v14 offset:54272
  ds_read_b64_tr_b16 v[68:69], v15 offset:53248
  ds_read_b64_tr_b16 v[70:71], v15 offset:54272
  ds_read_b128 v[32:35], v11 offset:49152
  ds_read_b128 v[36:39], v11 offset:53248
  ds_read_b64_tr_b16 v[72:73], v14 offset:57344
  ds_read_b64_tr_b16 v[74:75], v14 offset:58368
  ds_read_b64_tr_b16 v[76:77], v15 offset:57344
  ds_read_b64_tr_b16 v[78:79], v15 offset:58368
  ds_read_b128 v[40:43], v12 offset:49152
  ds_read_b128 v[44:47], v12 offset:53248
  ds_read_b64_tr_b16 v[80:81], v14 offset:61440
  ds_read_b64_tr_b16 v[82:83], v14 offset:62464
  ds_read_b64_tr_b16 v[84:85], v15 offset:61440
  ds_read_b64_tr_b16 v[86:87], v15 offset:62464
  ds_read_b128 v[48:51], v13 offset:49152
  ds_read_b128 v[52:55], v13 offset:53248
  s_add_u32 m0, s26, 0x8000
  s_nop 0
  buffer_load_dwordx4 v2, s[4:7], s22 offen lds
  s_add_u32 m0, s26, 0xa000
  s_nop 0
  buffer_load_dwordx4 v3, s[4:7], s22 offen lds
  s_add_u32 m0, s26, 0x18000
  s_nop 0
  buffer_load_dwordx4 v6, s[8:11], s23 offen lds
  s_add_u32 m0, s26, 0x1a000
  s_nop 0
  buffer_load_dwordx4 v7, s[8:11], s23 offen lds
  s_add_u32 s22, s22, 128
  s_add_u32 s23, s23, s24
  s_waitcnt vmcnt(8) lgkmcnt(0)
  s_branch L_d_52
L_n_51:
  ds_read_b64_tr_b16 v[56:57], v14 offset:49152
  ds_read_b64_tr_b16 v[58:59], v14 offset:50176
  ds_read_b64_tr_b16 v[60:61], v15 offset:49152
  ds_read_b64_tr_b16 v[62:63], v15 offset:50176
  ds_read_b128 v[24:27], v10 offset:49152
  ds_read_b128 v[28:31], v10 offset:53248
  ds_read_b64_tr_b16 v[64:65], v14 offset:53248
  ds_read_b64_tr_b16 v[66:67], v14 offset:54272
  ds_read_b64_tr_b16 v[68:69], v15 offset:53248
  ds_read_b64_tr_b16 v[70:71], v15 offset:54272
  ds_read_b128 v[32:35], v11 offset:49152
  ds_read_b128 v[36:39], v11 offset:53248
  ds_read_b64_tr_b16 v[72:73], v14 offset:57344
  ds_read_b64_tr_b16 v[74:75], v14 offset:58368
  ds_read_b64_tr_b16 v[76:77], v15 offset:57344
  ds_read_b64_tr_b16 v[78:79], v15 offset:58368
  ds_read_b128 v[40:43], v12 offset:49152
  ds_read_b128 v[44:47], v12 offset:53248
  ds_read_b64_tr_b16 v[80:81], v14 offset:61440
  ds_read_b64_tr_b16 v[82:83], v14 offset:62464
  ds_read_b64_tr_b16 v[84:85], v15 offset:61440
  ds_read_b64_tr_b16 v[86:87], v15 offset:62464
  ds_read_b128 v[48:51], v13 offset:49152
  ds_read_b128 v[52:55], v13 offset:53248
  s_waitcnt vmcnt(0) lgkmcnt(0)
L_d_52:
  s_barrier
  s_add_u32 s25, s25, 1
  s_add_u32 s27, s25, 3
  s_cmp_lt_u32 s27, s19
  s_cbranch_scc0 L_n_53
  v_mfma_f32_32x32x16_bf16 v[128:143], v[56:59], v[24:27], v[128:143]
  v_mfma_f32_32x32x16_bf16 v[160:175], v[60:63], v[24:27], v[160:175]
  s_add_u32 m0, s26, 0xc000
  s_nop 0
  buffer_load_dwordx4 v2, s[4:7], s22 offen lds
  v_mfma_f32_32x32x16_bf16 v[144:159], v[56:59], v[28:31], v[144:159]
  v_mfma_f32_32x32x16_bf16 v[176:191], v[60:63], v[28:31], v[176:191]
  v_mfma_f32_32x32x16_bf16 v[128:143], v[64:67], v[32:35], v[128:143]
  v_mfma_f32_32x32x16_bf16 v[160:175], v[68:71], v[32:35], v[160:175]
  s_add_u32 m0, s26, 0xe000
  s_nop 0
  buffer_load_dwordx4 v3, s[4:7], s22 offen lds
  v_mfma_f32_32x32x16_bf16 v[144:159], v[64:67], v[36:39], v[144:159]
  v_mfma_f32_32x32x16_bf16 v[176:191], v[68:71], v[36:39], v[176:191]
  v_mfma_f32_32x32x16_bf16 v[128:143], v[72:75], v[40:43], v[128:143]
  v_mfma_f32_32x32x16_bf16 v[160:175], v[76:79], v[40:43], v[160:175]
  s_add_u32 m0, s26, 0x1c000
  s_nop 0
  buffer_load_dwordx4 v6, s[8:11], s23 offen lds
  v_mfma_f32_32x32x16_bf16 v[144:159], v[72:75], v[44:47], v[144:159]
  v_mfma_f32_32x32x16_bf16 v[176:191], v[76:79], v[44:47], v[176:191]
  v_mfma_f32_32x32x16_bf16 v[128:143], v[80:83], v[48:51], v[128:143]
  v_mfma_f32_32x32x16_bf16 v[160:175], v[84:87], v[48:51], v[160:175]
  s_add_u32 m0, s26, 0x1e000
  s_nop 0
  buffer_load_dwordx4 v7, s[8:11], s23 offen lds
  s_add_u32 s22, s22, 128
  s_add_u32 s23, s23, s24
  v_mfma_f32_32x32x16_bf16 v[144:159], v[80:83], v[52:55], v[144:159]
  v_mfma_f32_32x32x16_bf16 v[176:191], v[84:87], v[52:55], v[176:191]
  s_waitcnt vmcnt(8)
  s_branch L_d_54
L_n_53:
  v_mfma_f32_32x32x16_bf16 v[128:143], v[56:59], v[24:27], v[128:143]
  v_mfma_f32_32x32x16_bf16 v[160:175], v[60:63], v[24:27], v[160:175]
  v_mfma_f32_32x32x16_bf16 v[144:159], v[56:59], v[28:31], v[144:159]
  v_mfma_f32_32x32x16_bf16 v[176:191], v[60:63], v[28:31], v[176:191]
  v_mfma_f32_32x32x16_bf16 v[128:143], v[64:67], v[32:35], v[128:143]
  v_mfma_f32_32x32x16_bf16 v[160:175], v[68:71], v[32:35], v[160:175]
  v_mfma_f32_32x32x16_bf16 v[144:159], v[64:67], v[36:39], v[144:159]
  v_mfma_f32_32x32x16_bf16 v[176:191], v[68:71], v[36:39], v[176:191]
  v_mfma_f32_32x32x16_bf16 v[128:143], v[72:75], v[40:43], v[128:143]
  v_mfma_f32_32x32x16_bf16 v[160:175], v[76:79], v[40:43], v[160:175]
  v_mfma_f32_32x32x16_bf16 v[144:159], v[72:75], v[44:47], v[144:159]
  v_mfma_f32_32x32x16_bf16 v[176:191], v[76:79], v[44:47], v[176:191]
  v_mfma_f32_32x32x16_bf16 v[128:143], v[80:83], v[48:51], v[128:143]
  v_mfma_f32_32x32x16_bf16 v[160:175], v[84:87], v[48:51], v[160:175]
  v_mfma_f32_32x32x16_bf16 v[144:159], v[80:83], v[52:55], v[144:159]
  v_mfma_f32_32x32x16_bf16 v[176:191], v[84:87], v[52:55], v[176:191]
  s_waitcnt vmcnt(0)
L_d_54:
  s_barrier
  s_add_u32 s25, s25, 1
  s_cmp_gt_u32 s25, s19
  s_cbranch_scc1 L_k3_epi
  s_branch L_k3_g1loop
L_k3_epi:
  s_lshl_b32 s27, s21, 13
  v_lshlrev_b32 v17, 4, v1
  v_add_u32 v18, s27, v17
  s_xor_b32 s27, s27, 0x8000
  v_add_u32 v19, s27, v17
  s_nop 7
  s_nop 3
  s_cmp_ge_u32 s21, 4
  s_cbranch_scc1 L_r1_55
  ds_write_b128 v18, v[160:163] offset:0
  ds_write_b128 v18, v[164:167] offset:1024
  ds_write_b128 v18, v[168:171] offset:2048
  ds_write_b128 v18, v[172:175] offset:3072
  ds_write_b128 v18, v[176:179] offset:4096
  ds_write_b128 v18, v[180:183] offset:5120
  ds_write_b128 v18, v[184:187] offset:6144
  ds_write_b128 v18, v[188:191] offset:7168
  v_mov_b32 v96, v128
  v_mov_b32 v97, v129
  v_mov_b32 v98, v130
  v_mov_b32 v99, v131
  v_mov_b32 v100, v132
  v_mov_b32 v101, v133
  v_mov_b32 v102, v134
  v_mov_b32 v103, v135
  v_mov_b32 v104, v136
  v_mov_b32 v105, v137
  v_mov_b32 v106, v138
  v_mov_b32 v107, v139
  v_mov_b32 v108, v140
  v_mov_b32 v109, v141
  v_mov_b32 v110, v142
  v_mov_b32 v111, v143
  v_mov_b32 v112, v144
  v_mov_b32 v113, v145
  v_mov_b32 v114, v146
  v_mov_b32 v115, v147
  v_mov_b32 v116, v148
  v_mov_b32 v117, v149
  v_mov_b32 v118, v150
  v_mov_b32 v119, v151
  v_mov_b32 v120, v152
  v_mov_b32 v121, v153
  v_mov_b32 v122, v154
  v_mov_b32 v123, v155
  v_mov_b32 v124, v156
  v_mov_b32 v125, v157
  v_mov_b32 v126, v158
  v_mov_b32 v127, v159
  s_branch L_r2_56
L_r1_55:
  ds_write_b128 v18, v[128:131] offset:0
  ds_write_b128 v18, v[132:135] offset:1024
  ds_write_b128 v18, v[136:139] offset:2048
  ds_write_b128 v18, v[140:143] offset:3072
  ds_write_b128 v18, v[144:147] offset:4096
  ds_write_b128 v18, v[148:151] offset:5120
  ds_write_b128 v18, v[152:155] offset:6144
  ds_write_b128 v18, v[156:159] offset:7168
  v_mov_b32 v96, v160
  v_mov_b32 v97, v161
  v_mov_b32 v98, v162
  v_mov_b32 v99, v163
  v_mov_b32 v100, v164
  v_mov_b32 v101, v165
  v_mov_b32 v102, v166
  v_mov_b32 v103, v167
  v_mov_b32 v104, v168
  v_mov_b32 v105, v169
  v_mov_b32 v106, v170
  v_mov_b32 v107, v171
  v_mov_b32 v108, v172
  v_mov_b32 v109, v173
  v_mov_b32 v110, v174
  v_mov_b32 v111, v175
  v_mov_b32 v112, v176
  v_mov_b32 v113, v177
  v_mov_b32 v114, v178
  v_mov_b32 v115, v179
  v_mov_b32 v116, v180
  v_mov_b32 v117, v181
  v_mov_b32 v118, v182
  v_mov_b32 v119, v183
  v_mov_b32 v120, v184
  v_mov_b32 v121, v185
  v_mov_b32 v122, v186
  v_mov_b32 v123, v187
  v_mov_b32 v124, v188
  v_mov_b32 v125, v189
  v_mov_b32 v126, v190
  v_mov_b32 v127, v191
L_r2_56:
  s_waitcnt lgkmcnt(0)
  s_barrier
  ds_read_b128 v[24:27], v19 offset:0
  ds_read_b128 v[28:31], v19 offset:1024
  ds_read_b128 v[32:35], v19 offset:2048
  ds_read_b128 v[36:39], v19 offset:3072
  ds_read_b128 v[40:43], v19 offset:4096
  ds_read_b128 v[44:47], v19 offset:5120
  ds_read_b128 v[48:51], v19 offset:6144
  ds_read_b128 v[52:55], v19 offset:7168
  s_waitcnt lgkmcnt(0)
  v_add_f32 v96, v96, v24
  v_add_f32 v97, v97, v25
  v_add_f32 v98, v98, v26
  v_add_f32 v99, v99, v27
  v_add_f32 v100, v100, v28
  v_add_f32 v101, v101, v29
  v_add_f32 v102, v102, v30
  v_add_f32 v103, v103, v31
  v_add_f32 v104, v104, v32
  v_add_f32 v105, v105, v33
  v_add_f32 v106, v106, v34
  v_add_f32 v107, v107, v35
  v_add_f32 v108, v108, v36
  v_add_f32 v109, v109, v37
  v_add_f32 v110, v110, v38
  v_add_f32 v111, v111, v39
  v_add_f32 v112, v112, v40
  v_add_f32 v113, v113, v41
  v_add_f32 v114, v114, v42
  v_add_f32 v115, v115, v43
  v_add_f32 v116, v116, v44
  v_add_f32 v117, v117, v45
  v_add_f32 v118, v118, v46
  v_add_f32 v119, v119, v47
  v_add_f32 v120, v120, v48
  v_add_f32 v121, v121, v49
  v_add_f32 v122, v122, v50
  v_add_f32 v123, v123, v51
  v_add_f32 v124, v124, v52
  v_add_f32 v125, v125, v53
  v_add_f32 v126, v126, v54
  v_add_f32 v127, v127, v55
  s_lshr_b32 s76, s21, 2
  s_lshl_b32 s76, s76, 6
  s_add_u32 s77, s76, 131072
  s_cmp_eq_u32 s64, 0
  s_cbranch_scc0 L_k3_epiB
  v_cvt_pk_bf16_f32 v56, v96, v97
  v_cvt_pk_bf16_f32 v57, v98, v99
  v_cvt_pk_bf16_f32 v58, v100, v101
  v_cvt_pk_bf16_f32 v59, v102, v103
  v_cvt_pk_bf16_f32 v60, v104, v105
  v_cvt_pk_bf16_f32 v61, v106, v107
  v_cvt_pk_bf16_f32 v62, v108, v109
  v_cvt_pk_bf16_f32 v63, v110, v111
  s_nop 1
  v_permlane32_swap_b32 v56, v58
  v_permlane32_swap_b32 v57, v59
  v_permlane32_swap_b32 v60, v62
  v_permlane32_swap_b32 v61, v63
  buffer_store_dwordx4 v[56:59], v16, s[12:15], s76 offen offset:0
  buffer_store_dwordx4 v[60:63], v16, s[12:15], s76 offen offset:32
  v_cvt_pk_bf16_f32 v56, v112, v113
  v_cvt_pk_bf16_f32 v57, v114, v115
  v_cvt_pk_bf16_f32 v58, v116, v117
  v_cvt_pk_bf16_f32 v59, v118, v119
  v_cvt_pk_bf16_f32 v60, v120, v121
  v_cvt_pk_bf16_f32 v61, v122, v123
  v_cvt_pk_bf16_f32 v62, v124, v125
  v_cvt_pk_bf16_f32 v63, v126, v127
  s_nop 1
  v_permlane32_swap_b32 v56, v58
  v_permlane32_swap_b32 v57, v59
  v_permlane32_swap_b32 v60, v62
  v_permlane32_swap_b32 v61, v63
  buffer_store_dwordx4 v[56:59], v16, s[12:15], s77 offen offset:0
  buffer_store_dwordx4 v[60:63], v16, s[12:15], s77 offen offset:32
  s_mul_i32 s76, s62, 524288
  s_mul_i32 s77, s63, 256
  s_add_u32 s76, s76, s77
  s_add_u32 s12, s54, 0x800
  s_addc_u32 s13, s55, 0
  s_add_u32 s12, s12, s76
  s_addc_u32 s13, s13, 0
  s_sub_u32 s14, 0x7ff800, s76
  s_mov_b32 s15, 0x00020000
  s_branch L_k3_recv
L_k3_epiB:
  s_lshl_b32 s27, s60, 16
  s_add_u32 s68, s58, 0x5000000
  s_addc_u32 s69, s59, 0
  s_add_u32 s68, s68, s27
  s_addc_u32 s69, s69, 0
  s_sub_u32 s70, 0x800000, s27
  s_mov_b32 s71, 0x00020000
  s_add_u32 s72, s56, 0x0
  s_addc_u32 s73, s57, 0
  s_mov_b32 s74, 0x100
  s_mov_b32 s75, 0x00020000
  s_lshl_b32 s27, s21, 12
  v_lshlrev_b32 v2, 4, v1
  v_add_u32 v2, s27, v2
  s_cmp_eq_u32 s61, 0
  s_cbranch_scc0 L_k3_t1
  s_mov_b32 s27, 32768
  buffer_store_dwordx4 v[112:115], v2, s[68:71], s27 offen offset:0 sc1
  buffer_store_dwordx4 v[116:119], v2, s[68:71], s27 offen offset:1024 sc1
  buffer_store_dwordx4 v[120:123], v2, s[68:71], s27 offen offset:2048 sc1
  buffer_store_dwordx4 v[124:127], v2, s[68:71], s27 offen offset:3072 sc1
  v_mov_b32 v192, v96
  v_mov_b32 v193, v97
  v_mov_b32 v194, v98
  v_mov_b32 v195, v99
  v_mov_b32 v196, v100
  v_mov_b32 v197, v101
  v_mov_b32 v198, v102
  v_mov_b32 v199, v103
  v_mov_b32 v200, v104
  v_mov_b32 v201, v105
  v_mov_b32 v202, v106
  v_mov_b32 v203, v107
  v_mov_b32 v204, v108
  v_mov_b32 v205, v109
  v_mov_b32 v206, v110
  v_mov_b32 v207, v111
  s_mov_b32 s65, s76
  s_branch L_k3_sent
L_k3_t1:
  s_mov_b32 s27, 0
  buffer_store_dwordx4 v[96:99], v2, s[68:71], s27 offen offset:0 sc1
  buffer_store_dwordx4 v[100:103], v2, s[68:71], s27 offen offset:1024 sc1
  buffer_store_dwordx4 v[104:107], v2, s[68:71], s27 offen offset:2048 sc1
  buffer_store_dwordx4 v[108:111], v2, s[68:71], s27 offen offset:3072 sc1
  v_mov_b32 v192, v112
  v_mov_b32 v193, v113
  v_mov_b32 v194, v114
  v_mov_b32 v195, v115
  v_mov_b32 v196, v116
  v_mov_b32 v197, v117
  v_mov_b32 v198, v118
  v_mov_b32 v199, v119
  v_mov_b32 v200, v120
  v_mov_b32 v201, v121
  v_mov_b32 v202, v122
  v_mov_b32 v203, v123
  v_mov_b32 v204, v124
  v_mov_b32 v205, v125
  v_mov_b32 v206, v126
  v_mov_b32 v207, v127
  s_mov_b32 s65, s77
L_k3_sent:
  s_waitcnt vmcnt(0)
  s_barrier
  s_cmp_eq_u32 s21, 0
  s_cbranch_scc0 L_k3_signalled
  s_lshr_b32 s27, s60, 1
  s_lshl_b32 s27, s27, 2
  s_and_b32 s28, s60, 1
  s_lshl_b32 s28, s28, 4
  v_mov_b32 v17, s27
  s_lshl_b32 s27, 1, s28
  v_mov_b32 v18, s27
  s_mov_b64 s[78:79], exec
  s_mov_b64 exec, 1
  buffer_atomic_add v18, v17, s[72:75], 0 offen
  s_waitcnt vmcnt(0)
  s_mov_b64 exec, s[78:79]
L_k3_signalled:
  s_cmp_eq_u32 s61, 0
  s_cbranch_scc1 L_k3_recv
  s_mov_b32 s64, 0
  s_mul_i32 s76, s62, 262144
  s_add_u32 s4, s58, 0x3800000
  s_addc_u32 s5, s59, 0
  s_add_u32 s4, s4, s76
  s_addc_u32 s5, s5, 0
  s_sub_u32 s6, 0x400000, s76
  s_mov_b32 s7, 0x00020000
  s_mul_i32 s76, s63, 256
  s_add_u32 s8, s40, 0x0
  s_addc_u32 s9, s41, 0
  s_add_u32 s8, s8, s76
  s_addc_u32 s9, s9, 0
  s_sub_u32 s10, 0x200000, s76
  s_mov_b32 s11, 0x00020000
  s_mul_i32 s76, s62, 524288
  s_mul_i32 s77, s63, 256
  s_add_u32 s76, s76, s77
  s_add_u32 s12, s54, 0x0
  s_addc_u32 s13, s55, 0
  s_add_u32 s12, s12, s76
  s_addc_u32 s13, s13, 0
  s_sub_u32 s14, 0x800000, s76
  s_mov_b32 s15, 0x00020000
  s_mov_b32 s16, 2048
  s_mov_b32 s19, 16
  s_branch L_k3_gemm
L_k3_recv:
  s_cmp_eq_u32 s21, 0
  s_cbranch_scc0 L_k3_wait
  s_lshr_b32 s27, s60, 1
  s_lshl_b32 s27, s27, 2
  s_and_b32 s28, s60, 1
  s_lshl_b32 s28, s28, 4
  v_mov_b32 v17, s27
  s_mov_b64 s[78:79], exec
  s_mov_b64 exec, 1
L_k3_poll:
  buffer_load_dword v19, v17, s[72:75], 0 offen sc1
  s_waitcnt vmcnt(0)
  v_readfirstlane_b32 s27, v19
  s_nop 3
  s_lshr_b32 s27, s27, s28
  s_and_b32 s27, s27, 0xffff
  s_cmp_ge_u32 s27, 2
  s_cbranch_scc1 L_k3_polldone
  s_sleep 2
  s_branch L_k3_poll
L_k3_polldone:
  s_mov_b64 exec, s[78:79]
L_k3_wait:
  s_barrier
  s_lshl_b32 s27, s21, 12
  v_lshlrev_b32 v2, 4, v1
  v_add_u32 v2, s27, v2
  s_lshl_b32 s27, s61, 15
  buffer_load_dwordx4 v[24:27], v2, s[68:71], s27 offen offset:0 sc1
  buffer_load_dwordx4 v[28:31], v2, s[68:71], s27 offen offset:1024 sc1
  buffer_load_dwordx4 v[32:35], v2, s[68:71], s27 offen offset:2048 sc1
  buffer_load_dwordx4 v[36:39], v2, s[68:71], s27 offen offset:3072 sc1
  s_waitcnt vmcnt(0)
  v_add_f32 v96, v192, v24
  v_add_f32 v97, v193, v25
  v_add_f32 v98, v194, v26
  v_add_f32 v99, v195, v27
  v_add_f32 v100, v196, v28
  v_add_f32 v101, v197, v29
  v_add_f32 v102, v198, v30
  v_add_f32 v103, v199, v31
  v_add_f32 v104, v200, v32
  v_add_f32 v105, v201, v33
  v_add_f32 v106, v202, v34
  v_add_f32 v107, v203, v35
  v_add_f32 v108, v204, v36
  v_add_f32 v109, v205, v37
  v_add_f32 v110, v206, v38
  v_add_f32 v111, v207, v39
  v_cvt_pk_bf16_f32 v56, v96, v97
  v_cvt_pk_bf16_f32 v57, v98, v99
  v_cvt_pk_bf16_f32 v58, v100, v101
  v_cvt_pk_bf16_f32 v59, v102, v103
  v_cvt_pk_bf16_f32 v60, v104, v105
  v_cvt_pk_bf16_f32 v61, v106, v107
  v_cvt_pk_bf16_f32 v62, v108, v109
  v_cvt_pk_bf16_f32 v63, v110, v111
  s_nop 1
  v_permlane32_swap_b32 v56, v58
  v_permlane32_swap_b32 v57, v59
  v_permlane32_swap_b32 v60, v62
  v_permlane32_swap_b32 v61, v63
  buffer_store_dwordx4 v[56:59], v16, s[12:15], s65 offen offset:0
  buffer_store_dwordx4 v[60:63], v16, s[12:15], s65 offen offset:32
L_k3_end:
  s_endpgm
L_code_end:
.section .rodata,"a"
.p2align 6
.amdhsa_kernel k1_proj_kernel
  .amdhsa_next_free_vgpr 256
  .amdhsa_next_free_sgpr 102
  .amdhsa_accum_offset 256
  .amdhsa_group_segment_fixed_size 0
  .amdhsa_kernarg_size 112
  .amdhsa_user_sgpr_count 2
  .amdhsa_user_sgpr_kernarg_segment_ptr 1
  .amdhsa_system_sgpr_workgroup_id_x 1
.end_amdhsa_kernel
.p2align 6
.amdhsa_kernel k2_attn_kernel
  .amdhsa_next_free_vgpr 256
  .amdhsa_next_free_sgpr 102
  .amdhsa_accum_offset 256
  .amdhsa_group_segment_fixed_size 0
  .amdhsa_kernarg_size 112
  .amdhsa_user_sgpr_count 2
  .amdhsa_user_sgpr_kernarg_segment_ptr 1
  .amdhsa_system_sgpr_workgroup_id_x 1
.end_amdhsa_kernel
.p2align 6
.amdhsa_kernel k3_out_kernel
  .amdhsa_next_free_vgpr 256
  .amdhsa_next_free_sgpr 102
  .amdhsa_accum_offset 256
  .amdhsa_group_segment_fixed_size 0
  .amdhsa_kernarg_size 112
  .amdhsa_user_sgpr_count 2
  .amdhsa_user_sgpr_kernarg_segment_ptr 1
  .amdhsa_system_sgpr_workgroup_id_x 1
.end_amdhsa_kernel
```
